```python
import torch

def _softmax(x, axis=-1):
    return torch.softmax(x, dim=axis)
def _gelu(x):
    return torch.nn.functional.gelu(x, approximate="tanh")
def _silu(x):
    return torch.nn.functional.silu(x)
def _sigmoid(x):
    return torch.sigmoid(x)
def _layernorm(x, axis=-1, eps=1e-5):
    m = x.mean(dim=axis, keepdim=True)
    v = x.var(dim=axis, keepdim=True, unbiased=False)
    return (x - m) / torch.sqrt(v + eps)
def _scatter_add(tgt, idx, src, axis=0):
    return tgt.clone().index_add_(axis, idx, src)
def _segment_sum(src, seg, n):
    out = torch.zeros((n,) + src.shape[1:], dtype=src.dtype)
    return out.index_add_(0, seg, src)
def _pad(x, pw):
    flat = tuple(v for pair in reversed(pw) for v in pair)
    return torch.nn.functional.pad(x, flat)

kernel_name = 'parallel_sum__mha_block_cached__dense_activation_relu__decode'

def setup_inputs():

    _w = (lambda a: (lambda t: t.to(torch.bfloat16) if t.is_floating_point() else t)(torch.as_tensor(a)))
    def _A_setup():
        B, Sq, D = 8, 1, 1024
        H, Sk, Dh = 32, 4096, 128
        return {
            "x": _w((lambda *s: torch.randn(*s, dtype=torch.bfloat16) * 0.05)(B, Sq, D)),
            "k_cache": _w((lambda *s: torch.randn(*s, dtype=torch.bfloat16) * 3.2)(B, H, Sk, Dh)),
            "v_cache": _w((lambda *s: torch.randn(*s, dtype=torch.bfloat16) * 1.6)(B, H, Sk, Dh)),
            "wq": _w((lambda *s: torch.randn(*s, dtype=torch.bfloat16) * 3.2)(D, H * Dh) * (D ** -0.5)),
            "wo": _w((lambda *s: torch.randn(*s, dtype=torch.bfloat16) * 1.6)(H * Dh, D) * ((H * Dh) ** -0.5)),
        }
    _A_in = _A_setup()

    def _B_setup():
        B, S, D, Dff = 8, 1, 1024, 3584
        return {
            "x": _w((lambda *s: torch.randn(*s, dtype=torch.bfloat16) * 0.05)(B, S, D)),
            "w1": _w((lambda *s: torch.randn(*s, dtype=torch.bfloat16) * 0.05)(D, Dff)),
            "w2": _w((lambda *s: torch.randn(*s, dtype=torch.bfloat16) * 0.05)(Dff, D)),
        }
    _B_in = _B_setup()

    return {
        "A_x": _A_in["x"],
        "A_k_cache": _A_in["k_cache"],
        "A_v_cache": _A_in["v_cache"],
        "A_wq": _A_in["wq"],
        "A_wo": _A_in["wo"],
        "B_x": _B_in["x"],
        "B_w1": _B_in["w1"],
        "B_w2": _B_in["w2"],
    }

def reference(A_x, A_k_cache, A_v_cache, A_wq, A_wo, B_x, B_w1, B_w2):
    def _A_ref(x, k_cache, v_cache, wq, wo):
        B, Sq, D = x.shape
        H, Dh = 32, 128
        q = (lambda x, *d: x.permute(*d))((x @ wq).reshape(B, Sq, H, Dh), 0, 2, 1, 3)
        scores = torch.einsum("bhqd,bhkd->bhqk", q, k_cache) * (Dh ** -0.5)
        p = _softmax(scores, axis=-1)
        o = torch.einsum("bhqk,bhkd->bhqd", p, v_cache)
        return (lambda x, *d: x.permute(*d))(o, 0, 2, 1, 3).reshape(B, Sq, H * Dh) @ wo

    def _B_ref(x, w1, w2):
        h = torch.einsum("bsd,df->bsf", x, w1)
        zero = torch.zeros_like(h)
        h = torch.maximum(h, zero)
        return torch.einsum("bsf,fd->bsd", h, w2)

    x = A_x
    xn = _layernorm(x, axis=-1)
    return x + _A_ref(xn, A_k_cache, A_v_cache, A_wq, A_wo) + _B_ref(xn, B_w1, B_w2)
```

```asm
; @launch grid=(256,1,1) block=(640,1,1) lds=143360
.amdgcn_target "amdgcn-amd-amdhsa--gfx950"
.text
.globl parallel_sum__mha_block_cached__dense_activation_relu__decode_kernel
.p2align 8
.type parallel_sum__mha_block_cached__dense_activation_relu__decode_kernel,@function
parallel_sum__mha_block_cached__dense_activation_relu__decode_kernel:
  s_cmp_ge_u32 s2, 256
  s_cbranch_scc1 L_exit
  s_load_dwordx16 s[32:47], s[0:1], 0
  s_load_dwordx2 s[48:49], s[0:1], 64
  s_load_dwordx2 s[50:51], s[0:1], 80
  v_lshrrev_b32 v4, 6, v0
  v_and_b32 v1, 63, v0
  v_readfirstlane_b32 s3, v4
  v_lshrrev_b32 v2, 4, v1
  v_and_b32 v3, 15, v1
  s_lshr_b32 s4, s2, 3
  s_and_b32 s4, s4, 7
  s_lshr_b32 s5, s2, 6
  s_lshl_b32 s5, s5, 3
  s_and_b32 s7, s2, 7
  s_add_u32 s5, s5, s7
  s_lshl_b32 s73, s4, 5
  s_add_u32 s73, s73, s5
  s_mov_b32 s72, 0x3fb8aa3b
  v_lshlrev_b32 v8, 1, v2
  v_xor_b32 v8, v3, v8
  v_lshlrev_b32 v8, 4, v8
  v_xor_b32 v9, 128, v8
  v_mov_b32 v40, 141888
  v_mov_b32 v41, 1
  s_waitcnt lgkmcnt(0)
  s_mov_b32 s16, s50
  s_and_b32 s17, s51, 0xffff
  s_mov_b32 s18, 10485760
  s_mov_b32 s19, 0x20000
  buffer_load_dword v5, off, s[16:19], 0 sc1
  s_cmp_eq_u32 s3, 8
  s_cbranch_scc1 L_poller
  s_cmp_eq_u32 s3, 9
  s_cbranch_scc1 L_loader
  s_mov_b32 s24, s32
  s_and_b32 s25, s33, 0xffff
  s_mov_b32 s26, 16384
  s_mov_b32 s27, 0x20000
  s_lshl_b32 s7, s3, 11
  v_lshlrev_b32 v6, 4, v1
  v_add_u32 v6, s7, v6
  s_lshl_b32 s64, s4, 8
  s_add_u32 s64, s64, s7
  v_lshlrev_b32 v7, 4, v3
  v_add_u32 v7, s64, v7
  buffer_load_dwordx4 v[108:111], v6, s[24:27], 0 offen
  buffer_load_dwordx4 v[112:115], v6, s[24:27], 0 offen offset:1024
  buffer_load_dwordx4 v[116:119], v7, s[24:27], 0 offen
  s_lshl_b32 s64, s4, 20
  s_lshl_b32 s65, s5, 8
  s_add_u32 s64, s64, s65
  s_add_u32 s20, s38, s64
  s_addc_u32 s21, s39, 0
  s_and_b32 s21, s21, 0xffff
  s_mov_b32 s22, 1040640
  s_mov_b32 s23, 0x20000
  v_lshlrev_b32 v10, 13, v2
  v_add_u32 v11, v10, v9
  v_add_u32 v10, v10, v8
  s_lshl_b32 s64, s3, 17
  s_lshl_b32 s65, s3, 12
  s_mov_b32 m0, s65
  s_add_u32 s65, s65, 1024
  buffer_load_dwordx4 v10, s[20:23], s64 offen nt lds
  s_add_u32 s64, s64, 32768
  s_mov_b32 m0, s65
  s_add_u32 s65, s65, 1024
  buffer_load_dwordx4 v10, s[20:23], s64 offen nt lds
  s_add_u32 s64, s64, 32768
  s_mov_b32 m0, s65
  s_add_u32 s65, s65, 1024
  buffer_load_dwordx4 v11, s[20:23], s64 offen nt lds
  s_add_u32 s64, s64, 32768
  s_mov_b32 m0, s65
  s_add_u32 s65, s65, 1024
  buffer_load_dwordx4 v11, s[20:23], s64 offen nt lds
  s_add_u32 s64, s64, 32768
  s_cmp_lg_u32 s3, 0
  s_cbranch_scc1 L_noinit
  v_mov_b32 v20, 0
  v_mov_b32 v21, 0
  v_mov_b32 v22, 0
  v_mov_b32 v23, 0
  ds_write_b128 v40, v[20:23]
  ds_write_b128 v40, v[20:23] offset:16
  ds_write_b128 v40, v[20:23] offset:32
  ds_write_b128 v40, v[20:23] offset:48
  s_waitcnt lgkmcnt(0)
L_noinit:
  s_lshl_b32 s64, s73, 20
  s_add_u32 s8, s34, s64
  s_addc_u32 s9, s35, 0
  s_and_b32 s9, s9, 0xffff
  s_mov_b32 s10, 0x100000
  s_mov_b32 s11, 0x20000
  s_add_u32 s12, s36, s64
  s_addc_u32 s13, s37, 0
  s_and_b32 s13, s13, 0xffff
  s_mov_b32 s14, 0x100000
  s_mov_b32 s15, 0x20000
  s_mul_i32 s7, s3, 1024
  v_lshlrev_b32 v19, 4, v1
  v_add_u32 v19, s7, v19
  v_mov_b32 v42, v19
  v_mov_b32 v158, v19
  s_barrier
  s_cmp_ge_u32 s3, 4
  s_cbranch_scc1 L_noring
  buffer_load_dwordx4 v[76:79], v19, s[8:11], 0 offen offset:0 nt
  v_add_u32 v19, 4096, v19
  buffer_load_dwordx4 v[80:83], v19, s[8:11], 0 offen offset:0 nt
  v_add_u32 v19, 4096, v19
  buffer_load_dwordx4 v[84:87], v19, s[8:11], 0 offen offset:0 nt
  v_add_u32 v19, 4096, v19
  buffer_load_dwordx4 v[88:91], v19, s[8:11], 0 offen offset:0 nt
  v_add_u32 v19, 4096, v19
  buffer_load_dwordx4 v[92:95], v19, s[8:11], 0 offen offset:0 nt
  v_add_u32 v19, 4096, v19
  buffer_load_dwordx4 v[96:99], v19, s[8:11], 0 offen offset:0 nt
  v_add_u32 v19, 4096, v19
  buffer_load_dwordx4 v[100:103], v19, s[8:11], 0 offen offset:0 nt
  v_add_u32 v19, 4096, v19
  buffer_load_dwordx4 v[104:107], v19, s[8:11], 0 offen offset:0 nt
  v_add_u32 v19, 4096, v19
  v_mov_b32 v42, v19
L_noring:
  s_mul_i32 s7, s3, 272
  s_add_u32 s7, s7, 131072
  v_lshlrev_b32 v36, 4, v3
  v_add_u32 v36, s7, v36
  s_lshl_b32 s7, s3, 1
  v_lshrrev_b32 v28, 2, v3
  v_and_b32 v29, 3, v3
  v_lshlrev_b32 v30, 3, v2
  v_add_u32 v30, v30, v28
  v_lshlrev_b32 v30, 8, v30
  v_lshrrev_b32 v31, 1, v29
  v_add_u32 v31, s7, v31
  v_lshlrev_b32 v32, 1, v28
  v_and_b32 v33, 1, v2
  v_lshlrev_b32 v33, 3, v33
  v_add_u32 v32, v32, v33
  v_xor_b32 v31, v31, v32
  v_lshlrev_b32 v31, 4, v31
  v_add_u32 v30, v30, v31
  v_and_b32 v29, 1, v29
  v_lshlrev_b32 v29, 3, v29
  v_add_u32 v164, v30, v29
  v_and_b32 v37, 7, v3
  v_mul_u32_u24 v37, 272, v37
  v_lshlrev_b32 v38, 4, v2
  v_add_u32 v37, v37, v38
  v_add_u32 v37, 131072, v37
  v_and_b32 v28, 1, v2
  v_lshlrev_b32 v28, 2, v28
  v_lshrrev_b32 v29, 1, v2
  v_lshlrev_b32 v29, 1, v29
  v_add_u32 v28, v28, v29
  v_and_b32 v29, 1, v3
  v_add_u32 v28, v28, v29
  v_lshlrev_b32 v28, 13, v28
  s_lshl_b32 s64, s5, 16
  s_lshl_b32 s65, s4, 10
  s_add_u32 s64, s64, s65
  s_lshl_b32 s65, s3, 7
  s_add_u32 s64, s64, s65
  s_add_u32 s64, s64, 1048576
  v_and_b32 v29, 14, v3
  v_lshlrev_b32 v29, 3, v29
  v_add_u32 v28, v28, v29
  v_add_u32 v39, s64, v28
  v_and_b32 v29, 1, v3
  v_cmp_eq_u32 s[80:81], 1, v29
  v_mov_b32 v21, 0xffff
  v_mov_b32 v22, 0xffff0000
  v_lshrrev_b32 v23, 1, v3
  v_cndmask_b32 v21, v21, v22, s[80:81]
  v_cmp_eq_u32 vcc, 0, v23
  s_nop 1
  v_cndmask_b32 v8, 0, v21, vcc
  v_cmp_eq_u32 vcc, 1, v23
  s_nop 1
  v_cndmask_b32 v9, 0, v21, vcc
  v_cmp_eq_u32 vcc, 2, v23
  s_nop 1
  v_cndmask_b32 v10, 0, v21, vcc
  v_cmp_eq_u32 vcc, 3, v23
  s_nop 1
  v_cndmask_b32 v11, 0, v21, vcc
  v_mov_b32 v12, 0
  v_mov_b32 v13, 0
  v_mov_b32 v14, 0
  v_mov_b32 v15, 0
  v_mov_b32 v16, 0xff800000
  v_mov_b32 v17, 0xff800000
  v_mov_b32 v18, 0
  v_lshlrev_b32 v38, 4, v3
  v_add_u32 v38, 133248, v38
  s_lshl_b32 s7, s3, 3
  s_add_u32 s7, s7, 137600
  v_mov_b32 v165, s7
  s_lshl_b32 s7, s3, 9
  s_add_u32 s7, s7, 133504
  v_lshlrev_b32 v163, 5, v3
  v_lshlrev_b32 v28, 4, v2
  v_add_u32 v163, v163, v28
  v_add_u32 v163, s7, v163
  s_cmp_ge_u32 s3, 4
  s_cbranch_scc1 L_wx_t
  s_waitcnt vmcnt(12)
  s_branch L_wx_done
L_wx_t:
  s_waitcnt vmcnt(4)
L_wx_done:
  v_readfirstlane_b32 s6, v5
  v_lshlrev_b32 v132, 16, v108
  v_and_b32 v133, 0xffff0000, v108
  v_lshlrev_b32 v134, 16, v109
  v_and_b32 v135, 0xffff0000, v109
  v_lshlrev_b32 v136, 16, v110
  v_and_b32 v137, 0xffff0000, v110
  v_lshlrev_b32 v138, 16, v111
  v_and_b32 v139, 0xffff0000, v111
  v_lshlrev_b32 v140, 16, v112
  v_and_b32 v141, 0xffff0000, v112
  v_lshlrev_b32 v142, 16, v113
  v_and_b32 v143, 0xffff0000, v113
  v_lshlrev_b32 v144, 16, v114
  v_and_b32 v145, 0xffff0000, v114
  v_lshlrev_b32 v146, 16, v115
  v_and_b32 v147, 0xffff0000, v115
  s_add_u32 s6, s6, 1
  s_and_b32 s79, s6, 0xff
  v_add_f32 v28, v132, v133
  v_add_f32 v29, v134, v135
  v_add_f32 v30, v136, v137
  v_add_f32 v31, v138, v139
  v_add_f32 v32, v140, v141
  v_add_f32 v33, v142, v143
  v_add_f32 v34, v144, v145
  v_add_f32 v35, v146, v147
  v_add_f32 v28, v28, v29
  v_add_f32 v30, v30, v31
  v_add_f32 v32, v32, v33
  v_add_f32 v34, v34, v35
  v_add_f32 v28, v28, v30
  v_add_f32 v32, v32, v34
  v_add_f32 v20, v28, v32
  s_nop 1
  v_add_f32_dpp v20, v20, v20 row_ror:8 row_mask:0xf bank_mask:0xf
  s_nop 1
  v_add_f32_dpp v20, v20, v20 row_ror:4 row_mask:0xf bank_mask:0xf
  s_nop 1
  v_add_f32_dpp v20, v20, v20 row_ror:2 row_mask:0xf bank_mask:0xf
  s_nop 1
  v_add_f32_dpp v20, v20, v20 row_ror:1 row_mask:0xf bank_mask:0xf
  v_mov_b32 v24, v20
  s_nop 1
  v_permlane16_swap_b32 v20, v24
  v_add_f32 v20, v20, v24
  v_mov_b32 v24, v20
  s_nop 1
  v_permlane32_swap_b32 v20, v24
  v_add_f32 v20, v20, v24
  v_mul_f32 v20, 0x3a800000, v20
  v_sub_f32 v132, v132, v20
  v_sub_f32 v133, v133, v20
  v_sub_f32 v134, v134, v20
  v_sub_f32 v135, v135, v20
  v_sub_f32 v136, v136, v20
  v_sub_f32 v137, v137, v20
  v_sub_f32 v138, v138, v20
  v_sub_f32 v139, v139, v20
  v_sub_f32 v140, v140, v20
  v_sub_f32 v141, v141, v20
  v_sub_f32 v142, v142, v20
  v_sub_f32 v143, v143, v20
  v_sub_f32 v144, v144, v20
  v_sub_f32 v145, v145, v20
  v_sub_f32 v146, v146, v20
  v_sub_f32 v147, v147, v20
  v_mul_f32 v22, v132, v132
  v_mul_f32 v28, v133, v133
  v_fmac_f32 v22, v134, v134
  v_fmac_f32 v28, v135, v135
  v_fmac_f32 v22, v136, v136
  v_fmac_f32 v28, v137, v137
  v_fmac_f32 v22, v138, v138
  v_fmac_f32 v28, v139, v139
  v_fmac_f32 v22, v140, v140
  v_fmac_f32 v28, v141, v141
  v_fmac_f32 v22, v142, v142
  v_fmac_f32 v28, v143, v143
  v_fmac_f32 v22, v144, v144
  v_fmac_f32 v28, v145, v145
  v_fmac_f32 v22, v146, v146
  v_fmac_f32 v28, v147, v147
  v_add_f32 v22, v22, v28
  s_nop 1
  v_add_f32_dpp v22, v22, v22 row_ror:8 row_mask:0xf bank_mask:0xf
  s_nop 1
  v_add_f32_dpp v22, v22, v22 row_ror:4 row_mask:0xf bank_mask:0xf
  s_nop 1
  v_add_f32_dpp v22, v22, v22 row_ror:2 row_mask:0xf bank_mask:0xf
  s_nop 1
  v_add_f32_dpp v22, v22, v22 row_ror:1 row_mask:0xf bank_mask:0xf
  v_mov_b32 v24, v22
  s_nop 1
  v_permlane16_swap_b32 v22, v24
  v_add_f32 v22, v22, v24
  v_mov_b32 v24, v22
  s_nop 1
  v_permlane32_swap_b32 v22, v24
  v_add_f32 v22, v22, v24
  v_mul_f32 v22, 0x3a800000, v22
  v_cvt_pk_bf16_f32 v28, v20, v22
  v_lshlrev_b32 v20, 16, v28
  v_and_b32 v22, 0xffff0000, v28
  v_add_f32 v22, 0x3727c5ac, v22
  v_cvt_pk_bf16_f32 v22, v22, v22
  v_and_b32 v22, 0xffff0000, v22
  v_sqrt_f32 v22, v22
  v_lshlrev_b32 v132, 16, v116
  v_and_b32 v133, 0xffff0000, v116
  v_lshlrev_b32 v134, 16, v117
  v_and_b32 v135, 0xffff0000, v117
  v_lshlrev_b32 v136, 16, v118
  v_and_b32 v137, 0xffff0000, v118
  v_lshlrev_b32 v138, 16, v119
  v_and_b32 v139, 0xffff0000, v119
  v_cvt_pk_bf16_f32 v22, v22, v22
  v_and_b32 v22, 0xffff0000, v22
  v_rcp_f32 v22, v22
  v_sub_f32 v132, v132, v20
  v_sub_f32 v133, v133, v20
  v_sub_f32 v134, v134, v20
  v_sub_f32 v135, v135, v20
  v_sub_f32 v136, v136, v20
  v_sub_f32 v137, v137, v20
  v_sub_f32 v138, v138, v20
  v_sub_f32 v139, v139, v20
  v_cvt_pk_bf16_f32 v28, v132, v133
  v_cvt_pk_bf16_f32 v29, v134, v135
  v_cvt_pk_bf16_f32 v30, v136, v137
  v_cvt_pk_bf16_f32 v31, v138, v139
  v_lshlrev_b32 v132, 16, v28
  v_and_b32 v133, 0xffff0000, v28
  v_lshlrev_b32 v134, 16, v29
  v_and_b32 v135, 0xffff0000, v29
  v_lshlrev_b32 v136, 16, v30
  v_and_b32 v137, 0xffff0000, v30
  v_lshlrev_b32 v138, 16, v31
  v_and_b32 v139, 0xffff0000, v31
  v_mul_f32 v132, v132, v22
  v_mul_f32 v133, v133, v22
  v_mul_f32 v134, v134, v22
  v_mul_f32 v135, v135, v22
  v_mul_f32 v136, v136, v22
  v_mul_f32 v137, v137, v22
  v_mul_f32 v138, v138, v22
  v_mul_f32 v139, v139, v22
  v_cvt_pk_bf16_f32 v140, v132, v133
  v_cvt_pk_bf16_f32 v141, v134, v135
  v_cvt_pk_bf16_f32 v142, v136, v137
  v_cvt_pk_bf16_f32 v143, v138, v139
  ds_write_b128 v36, v[140:143]
  v_mov_b32 v20, 0
  v_mov_b32 v21, 0
  v_mov_b32 v22, 0
  v_mov_b32 v23, 0
  v_mov_b32 v33, s6
  v_mov_b32 v35, s6
  s_cmp_ge_u32 s3, 4
  s_cbranch_scc1 L_wt_t
  s_waitcnt vmcnt(8) lgkmcnt(0)
  s_branch L_wt_done
L_wt_t:
  s_waitcnt vmcnt(0) lgkmcnt(0)
L_wt_done:
  s_mov_b64 exec, 1
  ds_add_u32 v40, v41 offset:0
  s_mov_b64 exec, -1
  s_mov_b32 s71, 0
L_sp0:
  ds_read_b32 v24, v40 offset:0
  s_add_u32 s71, s71, 1
  s_waitcnt lgkmcnt(0)
  v_cmp_ne_u32 vcc, 8, v24
  s_cbranch_vccz L_sp0_done
  s_cmp_lt_u32 s71, 1600000
  s_cbranch_scc1 L_sp0
L_sp0_done:
  ds_read_b128 v[108:111], v37 offset:0
  ds_read_b128 v[112:115], v37 offset:64
  ds_read_b128 v[116:119], v37 offset:128
  ds_read_b128 v[120:123], v37 offset:192
  ds_read_b64_tr_b16 v[124:125], v164 offset:0
  ds_read_b64_tr_b16 v[126:127], v164 offset:1024
  ds_read_b64_tr_b16 v[128:129], v164 offset:8192
  ds_read_b64_tr_b16 v[130:131], v164 offset:9216
  ds_read_b64_tr_b16 v[132:133], v164 offset:16384
  ds_read_b64_tr_b16 v[134:135], v164 offset:17408
  ds_read_b64_tr_b16 v[136:137], v164 offset:24576
  ds_read_b64_tr_b16 v[138:139], v164 offset:25600
  v_cmp_lt_u32 vcc, 31, v1
  s_waitcnt lgkmcnt(6)
  v_mfma_f32_16x16x32_bf16 v[20:23], v[108:111], v[124:127], v[20:23]
  s_waitcnt lgkmcnt(4)
  v_mfma_f32_16x16x32_bf16 v[20:23], v[112:115], v[128:131], v[20:23]
  s_waitcnt lgkmcnt(2)
  v_mfma_f32_16x16x32_bf16 v[20:23], v[116:119], v[132:135], v[20:23]
  s_waitcnt lgkmcnt(0)
  v_mfma_f32_16x16x32_bf16 v[20:23], v[120:123], v[136:139], v[20:23]
  s_nop 7
  s_nop 0
  v_cndmask_b32 v24, v20, v22, vcc
  v_cndmask_b32 v25, v21, v23, vcc
  s_nop 1
  v_mov_b32_dpp v26, v24 quad_perm:[1,0,3,2] row_mask:0xf bank_mask:0xf
  v_mov_b32_dpp v27, v25 quad_perm:[1,0,3,2] row_mask:0xf bank_mask:0xf
  s_nop 0
  v_cndmask_b32 v32, v24, v27, s[80:81]
  v_cndmask_b32 v34, v26, v25, s[80:81]
  buffer_store_dwordx4 v[32:35], v39, s[16:19], 0 offen sc1
  s_mov_b64 exec, 1
  ds_add_u32 v40, v41 offset:4
  s_mov_b64 exec, -1
  s_cmp_ge_u32 s3, 4
  s_cbranch_scc1 L_tcrew
  s_lshl_b32 s7, s3, 2
  s_add_u32 s7, s7, 141904
  v_mov_b32 v160, s7
  v_mov_b32 v161, 0
  v_mov_b32 v162, 0
  s_mov_b32 s74, 0
  s_mul_i32 s7, s3, 2064
  s_add_u32 s7, s7, 0
  v_mul_u32_u24 v26, 516, v2
  v_add_u32 v26, s7, v26
  v_mov_b32 v27, v26
  s_mov_b32 s71, 0
L_sp1:
  ds_read_b32 v24, v40 offset:52
  s_add_u32 s71, s71, 1
  s_waitcnt lgkmcnt(0)
  v_cmp_ne_u32 vcc, 1, v24
  s_cbranch_vccz L_sp1_done
  s_sleep 1
  s_cmp_lt_u32 s71, 1600000
  s_cbranch_scc1 L_sp1
L_sp1_done:
  buffer_load_dwordx4 v[44:47], v42, s[8:11], 0 offen offset:0 nt
  v_add_u32 v42, 4096, v42
  buffer_load_dwordx4 v[48:51], v42, s[8:11], 0 offen offset:0 nt
  v_add_u32 v42, 4096, v42
  buffer_load_dwordx4 v[52:55], v42, s[8:11], 0 offen offset:0 nt
  v_add_u32 v42, 4096, v42
  buffer_load_dwordx4 v[56:59], v42, s[8:11], 0 offen offset:0 nt
  v_add_u32 v42, 4096, v42
  buffer_load_dwordx4 v[60:63], v42, s[8:11], 0 offen offset:0 nt
  v_add_u32 v42, 4096, v42
  buffer_load_dwordx4 v[64:67], v42, s[8:11], 0 offen offset:0 nt
  v_add_u32 v42, 4096, v42
  buffer_load_dwordx4 v[68:71], v42, s[8:11], 0 offen offset:0 nt
  v_add_u32 v42, 4096, v42
  buffer_load_dwordx4 v[72:75], v42, s[8:11], 0 offen offset:0 nt
  v_add_u32 v42, 4096, v42
  s_mov_b32 s71, 0
L_sp2:
  ds_read_b32 v24, v40 offset:8
  s_add_u32 s71, s71, 1
  s_waitcnt lgkmcnt(0)
  v_cmp_ne_u32 vcc, 1, v24
  s_cbranch_vccz L_sp2_done
  s_cmp_lt_u32 s71, 1600000
  s_cbranch_scc1 L_sp2
L_sp2_done:
  ds_read_b128 v[4:7], v38
  s_mov_b32 s70, 248
  s_waitcnt lgkmcnt(0)
  s_waitcnt vmcnt(8)
  v_dot2_f32_bf16 v20, v76, v4, 0
  v_dot2_f32_bf16 v20, v77, v5, v20
  v_dot2_f32_bf16 v20, v78, v6, v20
  v_dot2_f32_bf16 v20, v79, v7, v20
  s_nop 2
  v_add_f32_dpp v20, v20, v20 row_ror:8 row_mask:0xf bank_mask:0xf
  s_nop 1
  v_add_f32_dpp v20, v20, v20 row_ror:4 row_mask:0xf bank_mask:0xf
  s_nop 1
  v_add_f32_dpp v20, v20, v20 row_ror:2 row_mask:0xf bank_mask:0xf
  s_nop 1
  v_add_f32_dpp v20, v20, v20 row_ror:1 row_mask:0xf bank_mask:0xf
  v_cvt_pk_bf16_f32 v24, v20, v20
  v_lshlrev_b32 v20, 16, v24
  v_mul_f32 v20, 0x3db504f3, v20
  v_cvt_pk_bf16_f32 v24, v20, v20
  ds_write_b16 v26, v24 offset:0
  v_lshlrev_b32 v20, 16, v24
  v_max_f32 v16, v16, v20
  v_add_u32 v161, 1, v161
  ds_write_b32 v160, v161
  v_dot2_f32_bf16 v20, v80, v4, 0
  v_dot2_f32_bf16 v20, v81, v5, v20
  v_dot2_f32_bf16 v20, v82, v6, v20
  v_dot2_f32_bf16 v20, v83, v7, v20
  s_nop 2
  v_add_f32_dpp v20, v20, v20 row_ror:8 row_mask:0xf bank_mask:0xf
  s_nop 1
  v_add_f32_dpp v20, v20, v20 row_ror:4 row_mask:0xf bank_mask:0xf
  s_nop 1
  v_add_f32_dpp v20, v20, v20 row_ror:2 row_mask:0xf bank_mask:0xf
  s_nop 1
  v_add_f32_dpp v20, v20, v20 row_ror:1 row_mask:0xf bank_mask:0xf
  v_cvt_pk_bf16_f32 v24, v20, v20
  v_lshlrev_b32 v20, 16, v24
  v_mul_f32 v20, 0x3db504f3, v20
  v_cvt_pk_bf16_f32 v24, v20, v20
  ds_write_b16 v26, v24 offset:2
  v_lshlrev_b32 v20, 16, v24
  v_max_f32 v16, v16, v20
  v_add_u32 v161, 1, v161
  ds_write_b32 v160, v161
  v_dot2_f32_bf16 v20, v84, v4, 0
  v_dot2_f32_bf16 v20, v85, v5, v20
  v_dot2_f32_bf16 v20, v86, v6, v20
  v_dot2_f32_bf16 v20, v87, v7, v20
  s_nop 2
  v_add_f32_dpp v20, v20, v20 row_ror:8 row_mask:0xf bank_mask:0xf
  s_nop 1
  v_add_f32_dpp v20, v20, v20 row_ror:4 row_mask:0xf bank_mask:0xf
  s_nop 1
  v_add_f32_dpp v20, v20, v20 row_ror:2 row_mask:0xf bank_mask:0xf
  s_nop 1
  v_add_f32_dpp v20, v20, v20 row_ror:1 row_mask:0xf bank_mask:0xf
  v_cvt_pk_bf16_f32 v24, v20, v20
  v_lshlrev_b32 v20, 16, v24
  v_mul_f32 v20, 0x3db504f3, v20
  v_cvt_pk_bf16_f32 v24, v20, v20
  ds_write_b16 v26, v24 offset:4
  v_lshlrev_b32 v20, 16, v24
  v_max_f32 v16, v16, v20
  v_add_u32 v161, 1, v161
  ds_write_b32 v160, v161
  v_dot2_f32_bf16 v20, v88, v4, 0
  v_dot2_f32_bf16 v20, v89, v5, v20
  v_dot2_f32_bf16 v20, v90, v6, v20
  v_dot2_f32_bf16 v20, v91, v7, v20
  s_nop 2
  v_add_f32_dpp v20, v20, v20 row_ror:8 row_mask:0xf bank_mask:0xf
  s_nop 1
  v_add_f32_dpp v20, v20, v20 row_ror:4 row_mask:0xf bank_mask:0xf
  s_nop 1
  v_add_f32_dpp v20, v20, v20 row_ror:2 row_mask:0xf bank_mask:0xf
  s_nop 1
  v_add_f32_dpp v20, v20, v20 row_ror:1 row_mask:0xf bank_mask:0xf
  v_cvt_pk_bf16_f32 v24, v20, v20
  v_lshlrev_b32 v20, 16, v24
  v_mul_f32 v20, 0x3db504f3, v20
  v_cvt_pk_bf16_f32 v24, v20, v20
  ds_write_b16 v26, v24 offset:6
  v_lshlrev_b32 v20, 16, v24
  v_max_f32 v16, v16, v20
  v_add_u32 v161, 1, v161
  ds_write_b32 v160, v161
  v_dot2_f32_bf16 v20, v92, v4, 0
  v_dot2_f32_bf16 v20, v93, v5, v20
  v_dot2_f32_bf16 v20, v94, v6, v20
  v_dot2_f32_bf16 v20, v95, v7, v20
  s_nop 2
  v_add_f32_dpp v20, v20, v20 row_ror:8 row_mask:0xf bank_mask:0xf
  s_nop 1
  v_add_f32_dpp v20, v20, v20 row_ror:4 row_mask:0xf bank_mask:0xf
  s_nop 1
  v_add_f32_dpp v20, v20, v20 row_ror:2 row_mask:0xf bank_mask:0xf
  s_nop 1
  v_add_f32_dpp v20, v20, v20 row_ror:1 row_mask:0xf bank_mask:0xf
  v_cvt_pk_bf16_f32 v24, v20, v20
  v_lshlrev_b32 v20, 16, v24
  v_mul_f32 v20, 0x3db504f3, v20
  v_cvt_pk_bf16_f32 v24, v20, v20
  ds_write_b16 v26, v24 offset:8
  v_lshlrev_b32 v20, 16, v24
  v_max_f32 v16, v16, v20
  v_add_u32 v161, 1, v161
  ds_write_b32 v160, v161
  v_dot2_f32_bf16 v20, v96, v4, 0
  v_dot2_f32_bf16 v20, v97, v5, v20
  v_dot2_f32_bf16 v20, v98, v6, v20
  v_dot2_f32_bf16 v20, v99, v7, v20
  s_nop 2
  v_add_f32_dpp v20, v20, v20 row_ror:8 row_mask:0xf bank_mask:0xf
  s_nop 1
  v_add_f32_dpp v20, v20, v20 row_ror:4 row_mask:0xf bank_mask:0xf
  s_nop 1
  v_add_f32_dpp v20, v20, v20 row_ror:2 row_mask:0xf bank_mask:0xf
  s_nop 1
  v_add_f32_dpp v20, v20, v20 row_ror:1 row_mask:0xf bank_mask:0xf
  v_cvt_pk_bf16_f32 v24, v20, v20
  v_lshlrev_b32 v20, 16, v24
  v_mul_f32 v20, 0x3db504f3, v20
  v_cvt_pk_bf16_f32 v24, v20, v20
  ds_write_b16 v26, v24 offset:10
  v_lshlrev_b32 v20, 16, v24
  v_max_f32 v16, v16, v20
  v_add_u32 v161, 1, v161
  ds_write_b32 v160, v161
  v_dot2_f32_bf16 v20, v100, v4, 0
  v_dot2_f32_bf16 v20, v101, v5, v20
  v_dot2_f32_bf16 v20, v102, v6, v20
  v_dot2_f32_bf16 v20, v103, v7, v20
  s_nop 2
  v_add_f32_dpp v20, v20, v20 row_ror:8 row_mask:0xf bank_mask:0xf
  s_nop 1
  v_add_f32_dpp v20, v20, v20 row_ror:4 row_mask:0xf bank_mask:0xf
  s_nop 1
  v_add_f32_dpp v20, v20, v20 row_ror:2 row_mask:0xf bank_mask:0xf
  s_nop 1
  v_add_f32_dpp v20, v20, v20 row_ror:1 row_mask:0xf bank_mask:0xf
  v_cvt_pk_bf16_f32 v24, v20, v20
  v_lshlrev_b32 v20, 16, v24
  v_mul_f32 v20, 0x3db504f3, v20
  v_cvt_pk_bf16_f32 v24, v20, v20
  ds_write_b16 v26, v24 offset:12
  v_lshlrev_b32 v20, 16, v24
  v_max_f32 v16, v16, v20
  v_add_u32 v161, 1, v161
  ds_write_b32 v160, v161
  v_dot2_f32_bf16 v20, v104, v4, 0
  v_dot2_f32_bf16 v20, v105, v5, v20
  v_dot2_f32_bf16 v20, v106, v6, v20
  v_dot2_f32_bf16 v20, v107, v7, v20
  s_nop 2
  v_add_f32_dpp v20, v20, v20 row_ror:8 row_mask:0xf bank_mask:0xf
  s_nop 1
  v_add_f32_dpp v20, v20, v20 row_ror:4 row_mask:0xf bank_mask:0xf
  s_nop 1
  v_add_f32_dpp v20, v20, v20 row_ror:2 row_mask:0xf bank_mask:0xf
  s_nop 1
  v_add_f32_dpp v20, v20, v20 row_ror:1 row_mask:0xf bank_mask:0xf
  v_cvt_pk_bf16_f32 v24, v20, v20
  v_lshlrev_b32 v20, 16, v24
  v_mul_f32 v20, 0x3db504f3, v20
  v_cvt_pk_bf16_f32 v24, v20, v20
  ds_write_b16 v26, v24 offset:14
  v_lshlrev_b32 v20, 16, v24
  v_max_f32 v16, v16, v20
  v_add_u32 v161, 1, v161
  ds_write_b32 v160, v161
  v_add_u32 v26, 16, v26
L_loop1:
  s_waitcnt lgkmcnt(0)
  v_readfirstlane_b32 s74, v162
  ds_read_b32 v162, v40 offset:48
  s_cmp_eq_u32 s74, 0
  s_cbranch_scc1 L_wk0
  s_waitcnt vmcnt(4)
L_wk0:
  s_waitcnt vmcnt(7)
  v_dot2_f32_bf16 v20, v44, v4, 0
  v_dot2_f32_bf16 v20, v45, v5, v20
  v_dot2_f32_bf16 v20, v46, v6, v20
  v_dot2_f32_bf16 v20, v47, v7, v20
  s_cmp_lg_u32 s70, 8
  s_cbranch_scc1 L_nsw0
  s_mov_b32 s8, s12
  s_mov_b32 s9, s13
  v_mov_b32 v42, v158
L_nsw0:
  buffer_load_dwordx4 v[44:47], v42, s[8:11], 0 offen offset:0 nt
  v_add_u32 v42, 4096, v42
  v_add_f32_dpp v20, v20, v20 row_ror:8 row_mask:0xf bank_mask:0xf
  s_nop 1
  v_add_f32_dpp v20, v20, v20 row_ror:4 row_mask:0xf bank_mask:0xf
  s_nop 1
  v_add_f32_dpp v20, v20, v20 row_ror:2 row_mask:0xf bank_mask:0xf
  s_nop 1
  v_add_f32_dpp v20, v20, v20 row_ror:1 row_mask:0xf bank_mask:0xf
  v_cvt_pk_bf16_f32 v24, v20, v20
  v_lshlrev_b32 v20, 16, v24
  v_mul_f32 v20, 0x3db504f3, v20
  v_cvt_pk_bf16_f32 v24, v20, v20
  ds_write_b16 v26, v24 offset:0
  v_lshlrev_b32 v20, 16, v24
  v_max_f32 v16, v16, v20
  v_add_u32 v161, 1, v161
  ds_write_b32 v160, v161
  s_sub_u32 s70, s70, 1
  s_cmp_eq_u32 s74, 0
  s_cbranch_scc1 L_wk1
  s_waitcnt vmcnt(4)
L_wk1:
  s_waitcnt vmcnt(7)
  v_dot2_f32_bf16 v20, v48, v4, 0
  v_dot2_f32_bf16 v20, v49, v5, v20
  v_dot2_f32_bf16 v20, v50, v6, v20
  v_dot2_f32_bf16 v20, v51, v7, v20
  s_cmp_lg_u32 s70, 8
  s_cbranch_scc1 L_nsw1
  s_mov_b32 s8, s12
  s_mov_b32 s9, s13
  v_mov_b32 v42, v158
L_nsw1:
  buffer_load_dwordx4 v[48:51], v42, s[8:11], 0 offen offset:0 nt
  v_add_u32 v42, 4096, v42
  v_add_f32_dpp v20, v20, v20 row_ror:8 row_mask:0xf bank_mask:0xf
  s_nop 1
  v_add_f32_dpp v20, v20, v20 row_ror:4 row_mask:0xf bank_mask:0xf
  s_nop 1
  v_add_f32_dpp v20, v20, v20 row_ror:2 row_mask:0xf bank_mask:0xf
  s_nop 1
  v_add_f32_dpp v20, v20, v20 row_ror:1 row_mask:0xf bank_mask:0xf
  v_cvt_pk_bf16_f32 v24, v20, v20
  v_lshlrev_b32 v20, 16, v24
  v_mul_f32 v20, 0x3db504f3, v20
  v_cvt_pk_bf16_f32 v24, v20, v20
  ds_write_b16 v26, v24 offset:2
  v_lshlrev_b32 v20, 16, v24
  v_max_f32 v16, v16, v20
  v_add_u32 v161, 1, v161
  ds_write_b32 v160, v161
  s_sub_u32 s70, s70, 1
  s_cmp_eq_u32 s74, 0
  s_cbranch_scc1 L_wk2
  s_waitcnt vmcnt(4)
L_wk2:
  s_waitcnt vmcnt(7)
  v_dot2_f32_bf16 v20, v52, v4, 0
  v_dot2_f32_bf16 v20, v53, v5, v20
  v_dot2_f32_bf16 v20, v54, v6, v20
  v_dot2_f32_bf16 v20, v55, v7, v20
  s_cmp_lg_u32 s70, 8
  s_cbranch_scc1 L_nsw2
  s_mov_b32 s8, s12
  s_mov_b32 s9, s13
  v_mov_b32 v42, v158
L_nsw2:
  buffer_load_dwordx4 v[52:55], v42, s[8:11], 0 offen offset:0 nt
  v_add_u32 v42, 4096, v42
  v_add_f32_dpp v20, v20, v20 row_ror:8 row_mask:0xf bank_mask:0xf
  s_nop 1
  v_add_f32_dpp v20, v20, v20 row_ror:4 row_mask:0xf bank_mask:0xf
  s_nop 1
  v_add_f32_dpp v20, v20, v20 row_ror:2 row_mask:0xf bank_mask:0xf
  s_nop 1
  v_add_f32_dpp v20, v20, v20 row_ror:1 row_mask:0xf bank_mask:0xf
  v_cvt_pk_bf16_f32 v24, v20, v20
  v_lshlrev_b32 v20, 16, v24
  v_mul_f32 v20, 0x3db504f3, v20
  v_cvt_pk_bf16_f32 v24, v20, v20
  ds_write_b16 v26, v24 offset:4
  v_lshlrev_b32 v20, 16, v24
  v_max_f32 v16, v16, v20
  v_add_u32 v161, 1, v161
  ds_write_b32 v160, v161
  s_sub_u32 s70, s70, 1
  s_cmp_eq_u32 s74, 0
  s_cbranch_scc1 L_wk3
  s_waitcnt vmcnt(4)
L_wk3:
  s_waitcnt vmcnt(7)
  v_dot2_f32_bf16 v20, v56, v4, 0
  v_dot2_f32_bf16 v20, v57, v5, v20
  v_dot2_f32_bf16 v20, v58, v6, v20
  v_dot2_f32_bf16 v20, v59, v7, v20
  s_cmp_lg_u32 s70, 8
  s_cbranch_scc1 L_nsw3
  s_mov_b32 s8, s12
  s_mov_b32 s9, s13
  v_mov_b32 v42, v158
L_nsw3:
  buffer_load_dwordx4 v[56:59], v42, s[8:11], 0 offen offset:0 nt
  v_add_u32 v42, 4096, v42
  v_add_f32_dpp v20, v20, v20 row_ror:8 row_mask:0xf bank_mask:0xf
  s_nop 1
  v_add_f32_dpp v20, v20, v20 row_ror:4 row_mask:0xf bank_mask:0xf
  s_nop 1
  v_add_f32_dpp v20, v20, v20 row_ror:2 row_mask:0xf bank_mask:0xf
  s_nop 1
  v_add_f32_dpp v20, v20, v20 row_ror:1 row_mask:0xf bank_mask:0xf
  v_cvt_pk_bf16_f32 v24, v20, v20
  v_lshlrev_b32 v20, 16, v24
  v_mul_f32 v20, 0x3db504f3, v20
  v_cvt_pk_bf16_f32 v24, v20, v20
  ds_write_b16 v26, v24 offset:6
  v_lshlrev_b32 v20, 16, v24
  v_max_f32 v16, v16, v20
  v_add_u32 v161, 1, v161
  ds_write_b32 v160, v161
  s_sub_u32 s70, s70, 1
  s_cmp_eq_u32 s74, 0
  s_cbranch_scc1 L_wk4
  s_waitcnt vmcnt(4)
L_wk4:
  s_waitcnt vmcnt(7)
  v_dot2_f32_bf16 v20, v60, v4, 0
  v_dot2_f32_bf16 v20, v61, v5, v20
  v_dot2_f32_bf16 v20, v62, v6, v20
  v_dot2_f32_bf16 v20, v63, v7, v20
  s_cmp_lg_u32 s70, 8
  s_cbranch_scc1 L_nsw4
  s_mov_b32 s8, s12
  s_mov_b32 s9, s13
  v_mov_b32 v42, v158
L_nsw4:
  buffer_load_dwordx4 v[60:63], v42, s[8:11], 0 offen offset:0 nt
  v_add_u32 v42, 4096, v42
  v_add_f32_dpp v20, v20, v20 row_ror:8 row_mask:0xf bank_mask:0xf
  s_nop 1
  v_add_f32_dpp v20, v20, v20 row_ror:4 row_mask:0xf bank_mask:0xf
  s_nop 1
  v_add_f32_dpp v20, v20, v20 row_ror:2 row_mask:0xf bank_mask:0xf
  s_nop 1
  v_add_f32_dpp v20, v20, v20 row_ror:1 row_mask:0xf bank_mask:0xf
  v_cvt_pk_bf16_f32 v24, v20, v20
  v_lshlrev_b32 v20, 16, v24
  v_mul_f32 v20, 0x3db504f3, v20
  v_cvt_pk_bf16_f32 v24, v20, v20
  ds_write_b16 v26, v24 offset:8
  v_lshlrev_b32 v20, 16, v24
  v_max_f32 v16, v16, v20
  v_add_u32 v161, 1, v161
  ds_write_b32 v160, v161
  s_sub_u32 s70, s70, 1
  s_cmp_eq_u32 s74, 0
  s_cbranch_scc1 L_wk5
  s_waitcnt vmcnt(4)
L_wk5:
  s_waitcnt vmcnt(7)
  v_dot2_f32_bf16 v20, v64, v4, 0
  v_dot2_f32_bf16 v20, v65, v5, v20
  v_dot2_f32_bf16 v20, v66, v6, v20
  v_dot2_f32_bf16 v20, v67, v7, v20
  s_cmp_lg_u32 s70, 8
  s_cbranch_scc1 L_nsw5
  s_mov_b32 s8, s12
  s_mov_b32 s9, s13
  v_mov_b32 v42, v158
L_nsw5:
  buffer_load_dwordx4 v[64:67], v42, s[8:11], 0 offen offset:0 nt
  v_add_u32 v42, 4096, v42
  v_add_f32_dpp v20, v20, v20 row_ror:8 row_mask:0xf bank_mask:0xf
  s_nop 1
  v_add_f32_dpp v20, v20, v20 row_ror:4 row_mask:0xf bank_mask:0xf
  s_nop 1
  v_add_f32_dpp v20, v20, v20 row_ror:2 row_mask:0xf bank_mask:0xf
  s_nop 1
  v_add_f32_dpp v20, v20, v20 row_ror:1 row_mask:0xf bank_mask:0xf
  v_cvt_pk_bf16_f32 v24, v20, v20
  v_lshlrev_b32 v20, 16, v24
  v_mul_f32 v20, 0x3db504f3, v20
  v_cvt_pk_bf16_f32 v24, v20, v20
  ds_write_b16 v26, v24 offset:10
  v_lshlrev_b32 v20, 16, v24
  v_max_f32 v16, v16, v20
  v_add_u32 v161, 1, v161
  ds_write_b32 v160, v161
  s_sub_u32 s70, s70, 1
  s_cmp_eq_u32 s74, 0
  s_cbranch_scc1 L_wk6
  s_waitcnt vmcnt(4)
L_wk6:
  s_waitcnt vmcnt(7)
  v_dot2_f32_bf16 v20, v68, v4, 0
  v_dot2_f32_bf16 v20, v69, v5, v20
  v_dot2_f32_bf16 v20, v70, v6, v20
  v_dot2_f32_bf16 v20, v71, v7, v20
  s_cmp_lg_u32 s70, 8
  s_cbranch_scc1 L_nsw6
  s_mov_b32 s8, s12
  s_mov_b32 s9, s13
  v_mov_b32 v42, v158
L_nsw6:
  buffer_load_dwordx4 v[68:71], v42, s[8:11], 0 offen offset:0 nt
  v_add_u32 v42, 4096, v42
  v_add_f32_dpp v20, v20, v20 row_ror:8 row_mask:0xf bank_mask:0xf
  s_nop 1
  v_add_f32_dpp v20, v20, v20 row_ror:4 row_mask:0xf bank_mask:0xf
  s_nop 1
  v_add_f32_dpp v20, v20, v20 row_ror:2 row_mask:0xf bank_mask:0xf
  s_nop 1
  v_add_f32_dpp v20, v20, v20 row_ror:1 row_mask:0xf bank_mask:0xf
  v_cvt_pk_bf16_f32 v24, v20, v20
  v_lshlrev_b32 v20, 16, v24
  v_mul_f32 v20, 0x3db504f3, v20
  v_cvt_pk_bf16_f32 v24, v20, v20
  ds_write_b16 v26, v24 offset:12
  v_lshlrev_b32 v20, 16, v24
  v_max_f32 v16, v16, v20
  v_add_u32 v161, 1, v161
  ds_write_b32 v160, v161
  s_sub_u32 s70, s70, 1
  s_cmp_eq_u32 s74, 0
  s_cbranch_scc1 L_wk7
  s_waitcnt vmcnt(4)
L_wk7:
  s_waitcnt vmcnt(7)
  v_dot2_f32_bf16 v20, v72, v4, 0
  v_dot2_f32_bf16 v20, v73, v5, v20
  v_dot2_f32_bf16 v20, v74, v6, v20
  v_dot2_f32_bf16 v20, v75, v7, v20
  s_cmp_lg_u32 s70, 8
  s_cbranch_scc1 L_nsw7
  s_mov_b32 s8, s12
  s_mov_b32 s9, s13
  v_mov_b32 v42, v158
L_nsw7:
  buffer_load_dwordx4 v[72:75], v42, s[8:11], 0 offen offset:0 nt
  v_add_u32 v42, 4096, v42
  v_add_f32_dpp v20, v20, v20 row_ror:8 row_mask:0xf bank_mask:0xf
  s_nop 1
  v_add_f32_dpp v20, v20, v20 row_ror:4 row_mask:0xf bank_mask:0xf
  s_nop 1
  v_add_f32_dpp v20, v20, v20 row_ror:2 row_mask:0xf bank_mask:0xf
  s_nop 1
  v_add_f32_dpp v20, v20, v20 row_ror:1 row_mask:0xf bank_mask:0xf
  v_cvt_pk_bf16_f32 v24, v20, v20
  v_lshlrev_b32 v20, 16, v24
  v_mul_f32 v20, 0x3db504f3, v20
  v_cvt_pk_bf16_f32 v24, v20, v20
  ds_write_b16 v26, v24 offset:14
  v_lshlrev_b32 v20, 16, v24
  v_max_f32 v16, v16, v20
  v_add_u32 v161, 1, v161
  ds_write_b32 v160, v161
  s_sub_u32 s70, s70, 1
  v_add_u32 v26, 16, v26
  s_cmp_lg_u32 s70, 0
  s_cbranch_scc1 L_loop1
L_pass2:
  v_mov_b32 v25, v16
  s_nop 1
  v_permlane16_swap_b32 v16, v25
  v_max_f32 v16, v16, v25
  v_mov_b32 v25, v16
  s_nop 1
  v_permlane32_swap_b32 v16, v25
  v_max_f32 v16, v16, v25
  s_waitcnt lgkmcnt(0)
  ds_read_u16 v25, v27
  v_mul_f32 v17, s72, v16
  s_mov_b32 s70, 256
L_loop2:
  s_waitcnt lgkmcnt(0)
  v_readfirstlane_b32 s74, v162
  ds_read_b32 v162, v40 offset:48
  s_waitcnt lgkmcnt(1)
  v_lshlrev_b32 v20, 16, v25
  ds_read_u16 v25, v27 offset:2
  v_fma_f32 v20, v20, s72, -v17
  v_exp_f32 v20, v20
  s_nop 0
  v_cvt_pk_bf16_f32 v24, v20, v20
  v_add_f32 v18, v18, v20
  v_and_b32 v28, v24, v8
  v_and_b32 v29, v24, v9
  v_and_b32 v30, v24, v10
  v_and_b32 v31, v24, v11
  v_add_u32 v161, 1, v161
  ds_write_b32 v160, v161
  s_cmp_eq_u32 s74, 0
  s_cbranch_scc1 L_wv0
  s_waitcnt vmcnt(4)
L_wv0:
  s_waitcnt vmcnt(7)
  s_nop 0
  v_mfma_f32_16x16x32_bf16 v[12:15], v[28:31], v[44:47], v[12:15]
  buffer_load_dwordx4 v[44:47], v42, s[8:11], 0 offen offset:0 nt
  v_add_u32 v42, 4096, v42
  s_sub_u32 s70, s70, 1
  s_waitcnt lgkmcnt(0)
  v_lshlrev_b32 v20, 16, v25
  ds_read_u16 v25, v27 offset:4
  v_fma_f32 v20, v20, s72, -v17
  v_exp_f32 v20, v20
  s_nop 0
  v_cvt_pk_bf16_f32 v24, v20, v20
  v_add_f32 v18, v18, v20
  v_and_b32 v28, v24, v8
  v_and_b32 v29, v24, v9
  v_and_b32 v30, v24, v10
  v_and_b32 v31, v24, v11
  v_add_u32 v161, 1, v161
  ds_write_b32 v160, v161
  s_cmp_eq_u32 s74, 0
  s_cbranch_scc1 L_wv1
  s_waitcnt vmcnt(4)
L_wv1:
  s_waitcnt vmcnt(7)
  s_nop 0
  v_mfma_f32_16x16x32_bf16 v[12:15], v[28:31], v[48:51], v[12:15]
  buffer_load_dwordx4 v[48:51], v42, s[8:11], 0 offen offset:0 nt
  v_add_u32 v42, 4096, v42
  s_sub_u32 s70, s70, 1
  s_waitcnt lgkmcnt(0)
  v_lshlrev_b32 v20, 16, v25
  ds_read_u16 v25, v27 offset:6
  v_fma_f32 v20, v20, s72, -v17
  v_exp_f32 v20, v20
  s_nop 0
  v_cvt_pk_bf16_f32 v24, v20, v20
  v_add_f32 v18, v18, v20
  v_and_b32 v28, v24, v8
  v_and_b32 v29, v24, v9
  v_and_b32 v30, v24, v10
  v_and_b32 v31, v24, v11
  v_add_u32 v161, 1, v161
  ds_write_b32 v160, v161
  s_cmp_eq_u32 s74, 0
  s_cbranch_scc1 L_wv2
  s_waitcnt vmcnt(4)
L_wv2:
  s_waitcnt vmcnt(7)
  s_nop 0
  v_mfma_f32_16x16x32_bf16 v[12:15], v[28:31], v[52:55], v[12:15]
  buffer_load_dwordx4 v[52:55], v42, s[8:11], 0 offen offset:0 nt
  v_add_u32 v42, 4096, v42
  s_sub_u32 s70, s70, 1
  s_waitcnt lgkmcnt(0)
  v_lshlrev_b32 v20, 16, v25
  ds_read_u16 v25, v27 offset:8
  v_fma_f32 v20, v20, s72, -v17
  v_exp_f32 v20, v20
  s_nop 0
  v_cvt_pk_bf16_f32 v24, v20, v20
  v_add_f32 v18, v18, v20
  v_and_b32 v28, v24, v8
  v_and_b32 v29, v24, v9
  v_and_b32 v30, v24, v10
  v_and_b32 v31, v24, v11
  v_add_u32 v161, 1, v161
  ds_write_b32 v160, v161
  s_cmp_eq_u32 s74, 0
  s_cbranch_scc1 L_wv3
  s_waitcnt vmcnt(4)
L_wv3:
  s_waitcnt vmcnt(7)
  s_nop 0
  v_mfma_f32_16x16x32_bf16 v[12:15], v[28:31], v[56:59], v[12:15]
  buffer_load_dwordx4 v[56:59], v42, s[8:11], 0 offen offset:0 nt
  v_add_u32 v42, 4096, v42
  s_sub_u32 s70, s70, 1
  s_waitcnt lgkmcnt(0)
  v_lshlrev_b32 v20, 16, v25
  ds_read_u16 v25, v27 offset:10
  v_fma_f32 v20, v20, s72, -v17
  v_exp_f32 v20, v20
  s_nop 0
  v_cvt_pk_bf16_f32 v24, v20, v20
  v_add_f32 v18, v18, v20
  v_and_b32 v28, v24, v8
  v_and_b32 v29, v24, v9
  v_and_b32 v30, v24, v10
  v_and_b32 v31, v24, v11
  v_add_u32 v161, 1, v161
  ds_write_b32 v160, v161
  s_cmp_eq_u32 s74, 0
  s_cbranch_scc1 L_wv4
  s_waitcnt vmcnt(4)
L_wv4:
  s_waitcnt vmcnt(7)
  s_nop 0
  v_mfma_f32_16x16x32_bf16 v[12:15], v[28:31], v[60:63], v[12:15]
  buffer_load_dwordx4 v[60:63], v42, s[8:11], 0 offen offset:0 nt
  v_add_u32 v42, 4096, v42
  s_sub_u32 s70, s70, 1
  s_waitcnt lgkmcnt(0)
  v_lshlrev_b32 v20, 16, v25
  ds_read_u16 v25, v27 offset:12
  v_fma_f32 v20, v20, s72, -v17
  v_exp_f32 v20, v20
  s_nop 0
  v_cvt_pk_bf16_f32 v24, v20, v20
  v_add_f32 v18, v18, v20
  v_and_b32 v28, v24, v8
  v_and_b32 v29, v24, v9
  v_and_b32 v30, v24, v10
  v_and_b32 v31, v24, v11
  v_add_u32 v161, 1, v161
  ds_write_b32 v160, v161
  s_cmp_eq_u32 s74, 0
  s_cbranch_scc1 L_wv5
  s_waitcnt vmcnt(4)
L_wv5:
  s_waitcnt vmcnt(7)
  s_nop 0
  v_mfma_f32_16x16x32_bf16 v[12:15], v[28:31], v[64:67], v[12:15]
  buffer_load_dwordx4 v[64:67], v42, s[8:11], 0 offen offset:0 nt
  v_add_u32 v42, 4096, v42
  s_sub_u32 s70, s70, 1
  s_waitcnt lgkmcnt(0)
  v_lshlrev_b32 v20, 16, v25
  ds_read_u16 v25, v27 offset:14
  v_fma_f32 v20, v20, s72, -v17
  v_exp_f32 v20, v20
  s_nop 0
  v_cvt_pk_bf16_f32 v24, v20, v20
  v_add_f32 v18, v18, v20
  v_and_b32 v28, v24, v8
  v_and_b32 v29, v24, v9
  v_and_b32 v30, v24, v10
  v_and_b32 v31, v24, v11
  v_add_u32 v161, 1, v161
  ds_write_b32 v160, v161
  s_cmp_eq_u32 s74, 0
  s_cbranch_scc1 L_wv6
  s_waitcnt vmcnt(4)
L_wv6:
  s_waitcnt vmcnt(7)
  s_nop 0
  v_mfma_f32_16x16x32_bf16 v[12:15], v[28:31], v[68:71], v[12:15]
  buffer_load_dwordx4 v[68:71], v42, s[8:11], 0 offen offset:0 nt
  v_add_u32 v42, 4096, v42
  s_sub_u32 s70, s70, 1
  s_waitcnt lgkmcnt(0)
  v_lshlrev_b32 v20, 16, v25
  ds_read_u16 v25, v27 offset:16
  v_fma_f32 v20, v20, s72, -v17
  v_exp_f32 v20, v20
  s_nop 0
  v_cvt_pk_bf16_f32 v24, v20, v20
  v_add_f32 v18, v18, v20
  v_and_b32 v28, v24, v8
  v_and_b32 v29, v24, v9
  v_and_b32 v30, v24, v10
  v_and_b32 v31, v24, v11
  v_add_u32 v161, 1, v161
  ds_write_b32 v160, v161
  s_cmp_eq_u32 s74, 0
  s_cbranch_scc1 L_wv7
  s_waitcnt vmcnt(4)
L_wv7:
  s_waitcnt vmcnt(7)
  s_nop 0
  v_mfma_f32_16x16x32_bf16 v[12:15], v[28:31], v[72:75], v[12:15]
  buffer_load_dwordx4 v[72:75], v42, s[8:11], 0 offen offset:0 nt
  v_add_u32 v42, 4096, v42
  s_sub_u32 s70, s70, 1
  v_add_u32 v27, 16, v27
  s_cmp_lg_u32 s70, 0
  s_cbranch_scc1 L_loop2
L_stail:
  v_mov_b32 v25, v18
  s_nop 1
  v_permlane16_swap_b32 v18, v25
  v_add_f32 v18, v18, v25
  v_mov_b32 v25, v18
  s_nop 1
  v_permlane32_swap_b32 v18, v25
  v_add_f32 v18, v18, v25
  v_mov_b32 v16, v17
  v_mov_b32 v17, v18
  ds_write_b64 v165, v[16:17]
  s_mov_b32 exec_hi, 0
  ds_write_b128 v163, v[12:15]
  s_mov_b64 exec, -1
  s_waitcnt lgkmcnt(0)
  s_barrier
  s_branch L_end
L_tcrew:
  s_sub_u32 s69, s3, 4
  s_lshl_b32 s7, s69, 2
  v_lshrrev_b32 v28, 2, v3
  v_and_b32 v29, 3, v3
  v_lshlrev_b32 v30, 3, v2
  v_add_u32 v30, v30, v28
  v_lshlrev_b32 v30, 8, v30
  v_lshrrev_b32 v31, 1, v29
  v_add_u32 v31, s7, v31
  v_lshlrev_b32 v32, 1, v28
  v_and_b32 v33, 1, v2
  v_lshlrev_b32 v33, 3, v33
  v_add_u32 v32, v32, v33
  v_xor_b32 v31, v31, v32
  v_lshlrev_b32 v31, 4, v31
  v_add_u32 v30, v30, v31
  v_and_b32 v29, 1, v29
  v_lshlrev_b32 v29, 3, v29
  v_add_u32 v20, v30, v29
  s_add_u32 s7, s7, 2
  v_lshrrev_b32 v28, 2, v3
  v_and_b32 v29, 3, v3
  v_lshlrev_b32 v30, 3, v2
  v_add_u32 v30, v30, v28
  v_lshlrev_b32 v30, 8, v30
  v_lshrrev_b32 v31, 1, v29
  v_add_u32 v31, s7, v31
  v_lshlrev_b32 v32, 1, v28
  v_and_b32 v33, 1, v2
  v_lshlrev_b32 v33, 3, v33
  v_add_u32 v32, v32, v33
  v_xor_b32 v31, v31, v32
  v_lshlrev_b32 v31, 4, v31
  v_add_u32 v30, v30, v31
  v_and_b32 v29, 1, v29
  v_lshlrev_b32 v29, 3, v29
  v_add_u32 v21, v30, v29
  v_and_b32 v28, 1, v2
  v_lshlrev_b32 v28, 2, v28
  v_and_b32 v29, 3, v3
  v_add_u32 v28, v28, v29
  v_lshlrev_b32 v28, 12, v28
  v_lshrrev_b32 v29, 2, v3
  v_lshlrev_b32 v29, 4, v29
  v_add_u32 v28, v28, v29
  s_lshl_b32 s64, s5, 15
  s_lshl_b32 s65, s4, 9
  s_add_u32 s64, s64, s65
  v_lshrrev_b32 v29, 1, v2
  v_lshlrev_b32 v29, 6, v29
  v_add_u32 v28, v28, v29
  s_add_u32 s64, s64, 3145728
  v_add_u32 v56, s64, v28
  v_and_b32 v29, 1, v3
  v_cmp_eq_u32 s[80:81], 1, v29
  v_and_b32 v29, 2, v3
  v_cmp_eq_u32 s[82:83], 2, v29
  s_lshl_b32 s7, s69, 7
  v_add_u32 v56, s7, v56
  v_mov_b32 v33, 0xffffff00
  v_mov_b32 v44, 0
  v_mov_b32 v45, 0
  v_mov_b32 v46, 0
  v_mov_b32 v47, 0
  v_mov_b32 v48, 0
  v_mov_b32 v49, 0
  v_mov_b32 v50, 0
  v_mov_b32 v51, 0
  s_mov_b32 s71, 0
L_sp3:
  ds_read_b32 v28, v40 offset:56
  s_add_u32 s71, s71, 1
  s_waitcnt lgkmcnt(0)
  v_cmp_ne_u32 vcc, 1, v28
  s_cbranch_vccz L_sp3_done
  s_sleep 2
  s_cmp_lt_u32 s71, 1600000
  s_cbranch_scc1 L_sp3
L_sp3_done:
  ds_read_b64_tr_b16 v[124:125], v20 offset:32768
  ds_read_b64_tr_b16 v[126:127], v20 offset:33792
  ds_read_b64_tr_b16 v[128:129], v20 offset:40960
  ds_read_b64_tr_b16 v[130:131], v20 offset:41984
  ds_read_b64_tr_b16 v[132:133], v20 offset:49152
  ds_read_b64_tr_b16 v[134:135], v20 offset:50176
  ds_read_b64_tr_b16 v[136:137], v20 offset:57344
  ds_read_b64_tr_b16 v[138:139], v20 offset:58368
  ds_read_b64_tr_b16 v[140:141], v21 offset:32768
  ds_read_b64_tr_b16 v[142:143], v21 offset:33792
  ds_read_b64_tr_b16 v[144:145], v21 offset:40960
  ds_read_b64_tr_b16 v[146:147], v21 offset:41984
  ds_read_b64_tr_b16 v[148:149], v21 offset:49152
  ds_read_b64_tr_b16 v[150:151], v21 offset:50176
  ds_read_b64_tr_b16 v[152:153], v21 offset:57344
  ds_read_b64_tr_b16 v[154:155], v21 offset:58368
  v_cmp_lt_u32 vcc, 31, v1
  s_waitcnt lgkmcnt(0)
  v_mfma_f32_16x16x32_bf16 v[44:47], v[108:111], v[124:127], v[44:47]
  v_mfma_f32_16x16x32_bf16 v[48:51], v[108:111], v[140:143], v[48:51]
  v_mfma_f32_16x16x32_bf16 v[44:47], v[112:115], v[128:131], v[44:47]
  v_mfma_f32_16x16x32_bf16 v[48:51], v[112:115], v[144:147], v[48:51]
  v_mfma_f32_16x16x32_bf16 v[44:47], v[116:119], v[132:135], v[44:47]
  v_mfma_f32_16x16x32_bf16 v[48:51], v[116:119], v[148:151], v[48:51]
  v_mfma_f32_16x16x32_bf16 v[44:47], v[120:123], v[136:139], v[44:47]
  v_mfma_f32_16x16x32_bf16 v[48:51], v[120:123], v[152:155], v[48:51]
  s_nop 7
  s_nop 0
  v_cndmask_b32 v44, v44, v48, vcc
  v_cndmask_b32 v45, v45, v49, vcc
  v_cndmask_b32 v46, v46, v50, vcc
  v_cndmask_b32 v47, v47, v51, vcc
  s_nop 0
  v_mov_b32_dpp v52, v45 quad_perm:[1,0,3,2] row_mask:0xf bank_mask:0xf
  v_mov_b32_dpp v53, v44 quad_perm:[1,0,3,2] row_mask:0xf bank_mask:0xf
  v_mov_b32_dpp v54, v47 quad_perm:[1,0,3,2] row_mask:0xf bank_mask:0xf
  v_mov_b32_dpp v55, v46 quad_perm:[1,0,3,2] row_mask:0xf bank_mask:0xf
  v_cndmask_b32 v44, v44, v52, s[80:81]
  v_cndmask_b32 v45, v53, v45, s[80:81]
  v_cndmask_b32 v46, v46, v54, s[80:81]
  v_cndmask_b32 v47, v55, v47, s[80:81]
  s_nop 0
  v_mov_b32_dpp v52, v46 quad_perm:[2,3,0,1] row_mask:0xf bank_mask:0xf
  v_mov_b32_dpp v53, v47 quad_perm:[2,3,0,1] row_mask:0xf bank_mask:0xf
  v_mov_b32_dpp v54, v44 quad_perm:[2,3,0,1] row_mask:0xf bank_mask:0xf
  v_mov_b32_dpp v55, v45 quad_perm:[2,3,0,1] row_mask:0xf bank_mask:0xf
  v_cndmask_b32 v44, v44, v52, s[82:83]
  v_cndmask_b32 v45, v45, v53, s[82:83]
  v_cndmask_b32 v46, v54, v46, s[82:83]
  v_cndmask_b32 v47, v55, v47, s[82:83]
  v_add_u32 v44, 0x80, v44
  v_add_u32 v45, 0x80, v45
  v_add_u32 v46, 0x80, v46
  v_add_u32 v47, 0x80, v47
  v_and_or_b32 v44, v44, v33, s79
  v_and_or_b32 v45, v45, v33, s79
  v_and_or_b32 v46, v46, v33, s79
  v_and_or_b32 v47, v47, v33, s79
  buffer_store_dwordx4 v[44:47], v56, s[16:19], 0 offen sc1 nt
  s_mov_b64 exec, 1
  ds_add_u32 v40, v41 offset:12
  s_mov_b64 exec, -1
  v_add_u32 v20, 0x10000, v20
  v_add_u32 v21, 0x10000, v21
  s_lshl_b32 s64, s5, 12
  v_and_b32 v24, 31, v1
  v_lshlrev_b32 v24, 4, v24
  v_lshrrev_b32 v23, 5, v1
  v_lshlrev_b32 v23, 9, v23
  v_add_u32 v23, v23, v24
  s_lshl_b32 s65, s69, 10
  s_add_u32 s65, s65, s64
  s_add_u32 s65, s65, 5373952
  v_add_u32 v23, s65, v23
  v_subrev_u32 v22, 131072, v23
  v_lshrrev_b32 v25, 5, v1
  s_lshl_b32 s7, s69, 1
  v_add_u32 v25, s7, v25
  v_mul_u32_u24 v25, 272, v25
  v_and_b32 v28, 31, v1
  v_lshlrev_b32 v28, 3, v28
  v_add_u32 v25, v25, v28
  v_add_u32 v25, 137664, v25
  v_and_b32 v26, 7, v3
  v_mul_u32_u24 v26, 272, v26
  v_lshlrev_b32 v28, 4, v2
  v_add_u32 v26, v26, v28
  v_add_u32 v26, 137664, v26
  v_lshrrev_b32 v27, 1, v2
  v_lshlrev_b32 v27, 14, v27
  v_and_b32 v28, 1, v2
  v_lshlrev_b32 v28, 13, v28
  v_add_u32 v27, v27, v28
  v_lshrrev_b32 v28, 3, v3
  v_lshlrev_b32 v28, 12, v28
  v_add_u32 v27, v27, v28
  v_and_b32 v28, 7, v3
  v_lshlrev_b32 v28, 4, v28
  v_add_u32 v27, v27, v28
  s_lshl_b32 s64, s4, 17
  s_lshl_b32 s65, s69, 15
  s_add_u32 s64, s64, s65
  s_lshl_b32 s65, s5, 7
  s_add_u32 s64, s64, s65
  s_add_u32 s64, s64, 6291456
  v_add_u32 v27, s64, v27
  v_add_u32 v37, 133504, v24
  s_lshl_b32 s64, s5, 3
  s_add_u32 s64, s64, s4
  s_lshl_b32 s64, s64, 9
  s_add_u32 s64, s64, 5242880
  v_add_u32 v38, s64, v24
  s_lshl_b32 s64, s73, 12
  s_add_u32 s64, s64, 6291456
  v_lshlrev_b32 v39, 4, v1
  v_add_u32 v39, s64, v39
  s_lshr_b32 s64, s73, 2
  s_lshl_b32 s64, s64, 5
  s_and_b32 s65, s73, 1
  s_lshl_b32 s65, s65, 4
  s_add_u32 s64, s64, s65
  s_and_b32 s65, s73, 2
  s_lshl_b32 s65, s65, 12
  s_add_u32 s64, s64, s65
  v_and_b32 v43, 7, v1
  v_lshlrev_b32 v43, 1, v43
  v_add_u32 v43, s64, v43
  v_add_u32 v42, 0x1000, v43
  buffer_load_ushort v156, v43, s[24:27], 0 offen
  buffer_load_ushort v157, v43, s[24:27], 0 offen offset:2048
  buffer_load_ushort v158, v42, s[24:27], 0 offen
  buffer_load_ushort v159, v42, s[24:27], 0 offen offset:2048
  s_mov_b32 s28, s48
  s_and_b32 s29, s49, 0xffff
  s_mov_b32 s30, 16384
  s_mov_b32 s31, 0x20000
  v_mov_b32 v12, 0
  v_mov_b32 v13, 0
  v_mov_b32 v14, 0
  v_mov_b32 v15, 0
  v_mov_b32 v16, 0
  v_mov_b32 v17, 0
  v_mov_b32 v18, 0
  v_mov_b32 v19, 0
  s_mov_b32 s71, 0
L_sp4:
  ds_read_b32 v28, v40 offset:32
  s_add_u32 s71, s71, 1
  s_waitcnt lgkmcnt(0)
  v_cmp_ne_u32 vcc, 1, v28
  s_cbranch_vccz L_sp4_done
  s_sleep 8
  s_cmp_lt_u32 s71, 1600000
  s_cbranch_scc1 L_sp4
L_sp4_done:
  ds_read_b64_tr_b16 v[44:45], v20 offset:0
  ds_read_b64_tr_b16 v[46:47], v20 offset:1024
  ds_read_b64_tr_b16 v[48:49], v20 offset:8192
  ds_read_b64_tr_b16 v[50:51], v20 offset:9216
  ds_read_b64_tr_b16 v[52:53], v20 offset:16384
  ds_read_b64_tr_b16 v[54:55], v20 offset:17408
  ds_read_b64_tr_b16 v[56:57], v20 offset:24576
  ds_read_b64_tr_b16 v[58:59], v20 offset:25600
  ds_read_b64_tr_b16 v[60:61], v21 offset:0
  ds_read_b64_tr_b16 v[62:63], v21 offset:1024
  ds_read_b64_tr_b16 v[64:65], v21 offset:8192
  ds_read_b64_tr_b16 v[66:67], v21 offset:9216
  ds_read_b64_tr_b16 v[68:69], v21 offset:16384
  ds_read_b64_tr_b16 v[70:71], v21 offset:17408
  ds_read_b64_tr_b16 v[72:73], v21 offset:24576
  ds_read_b64_tr_b16 v[74:75], v21 offset:25600
  s_waitcnt lgkmcnt(0)
  ds_read_b64_tr_b16 v[76:77], v20 offset:32768
  ds_read_b64_tr_b16 v[78:79], v20 offset:33792
  ds_read_b64_tr_b16 v[80:81], v20 offset:40960
  ds_read_b64_tr_b16 v[82:83], v20 offset:41984
  ds_read_b64_tr_b16 v[84:85], v20 offset:49152
  ds_read_b64_tr_b16 v[86:87], v20 offset:50176
  ds_read_b64_tr_b16 v[88:89], v20 offset:57344
  ds_read_b64_tr_b16 v[90:91], v20 offset:58368
  ds_read_b64_tr_b16 v[92:93], v21 offset:32768
  ds_read_b64_tr_b16 v[94:95], v21 offset:33792
  ds_read_b64_tr_b16 v[96:97], v21 offset:40960
  ds_read_b64_tr_b16 v[98:99], v21 offset:41984
  ds_read_b64_tr_b16 v[100:101], v21 offset:49152
  ds_read_b64_tr_b16 v[102:103], v21 offset:50176
  ds_read_b64_tr_b16 v[104:105], v21 offset:57344
  ds_read_b64_tr_b16 v[106:107], v21 offset:58368
  s_mov_b32 s71, 0
L_sp5:
  ds_read_b32 v28, v40 offset:16
  s_add_u32 s71, s71, 1
  s_waitcnt lgkmcnt(0)
  v_cmp_gt_u32 vcc, 192, v28
  s_cbranch_vccz L_sp5_done
  s_sleep 64
  s_cmp_lt_u32 s71, 1600000
  s_cbranch_scc1 L_sp5
L_sp5_done:
  s_mov_b32 s71, 0
L_th:
  buffer_load_dwordx4 v[108:111], v23, s[16:19], 0 offen sc1 nt
  s_waitcnt vmcnt(0)
  v_xor_b32 v28, s6, v109
  v_xor_b32 v29, s6, v111
  v_or_b32 v28, v28, v29
  v_cmp_ne_u32 vcc, 0, v28
  s_add_u32 s71, s71, 1
  s_cbranch_vccz L_th_done
  s_sleep 32
  s_cmp_lt_u32 s71, 400000
  s_cbranch_scc1 L_th
L_th_done:
  ds_write2_b32 v25, v108, v110 offset0:0 offset1:1
  s_waitcnt lgkmcnt(0)
  s_mov_b64 exec, 1
  ds_add_u32 v40, v41 offset:40
  s_mov_b64 exec, -1
  s_mov_b32 s71, 0
L_sp6:
  ds_read_b32 v28, v40 offset:40
  s_add_u32 s71, s71, 1
  s_waitcnt lgkmcnt(0)
  v_cmp_ne_u32 vcc, 4, v28
  s_cbranch_vccz L_sp6_done
  s_sleep 2
  s_cmp_lt_u32 s71, 1600000
  s_cbranch_scc1 L_sp6
L_sp6_done:
  ds_read_b128 v[108:111], v26 offset:0
  ds_read_b128 v[112:115], v26 offset:64
  ds_read_b128 v[116:119], v26 offset:128
  ds_read_b128 v[120:123], v26 offset:192
  s_waitcnt lgkmcnt(0)
  v_mfma_f32_16x16x32_bf16 v[12:15], v[108:111], v[76:79], v[12:15]
  v_mfma_f32_16x16x32_bf16 v[16:19], v[108:111], v[92:95], v[16:19]
  v_mfma_f32_16x16x32_bf16 v[12:15], v[112:115], v[80:83], v[12:15]
  v_mfma_f32_16x16x32_bf16 v[16:19], v[112:115], v[96:99], v[16:19]
  v_mfma_f32_16x16x32_bf16 v[12:15], v[116:119], v[84:87], v[12:15]
  v_mfma_f32_16x16x32_bf16 v[16:19], v[116:119], v[100:103], v[16:19]
  v_mfma_f32_16x16x32_bf16 v[12:15], v[120:123], v[88:91], v[12:15]
  v_mfma_f32_16x16x32_bf16 v[16:19], v[120:123], v[104:107], v[16:19]
  v_mov_b32 v141, s6
  v_mov_b32 v143, s6
  v_mov_b32 v33, 0xffffff00
  v_mov_b32 v36, 137600
  v_cmp_lt_u32 s[82:83], 31, v1
  s_barrier
  s_cmp_lg_u32 s3, 4
  s_cbranch_scc1 L_x2
  ds_read_b128 v[108:111], v36
  ds_read_b128 v[112:115], v36 offset:16
  ds_read_b128 v[116:119], v37 offset:0
  ds_read_b128 v[120:123], v37 offset:512
  ds_read_b128 v[124:127], v37 offset:1024
  ds_read_b128 v[128:131], v37 offset:1536
  s_waitcnt lgkmcnt(4)
  v_max3_f32 v28, v108, v110, v112
  v_max_f32 v28, v28, v114
  v_sub_f32 v108, v108, v28
  v_sub_f32 v110, v110, v28
  v_sub_f32 v112, v112, v28
  v_sub_f32 v114, v114, v28
  v_exp_f32 v108, v108
  v_exp_f32 v110, v110
  v_exp_f32 v112, v112
  v_exp_f32 v114, v114
  v_mul_f32 v29, v108, v109
  v_fmac_f32 v29, v110, v111
  v_fmac_f32 v29, v112, v113
  v_fmac_f32 v29, v114, v115
  v_rcp_f32 v29, v29
  s_waitcnt lgkmcnt(0)
  v_mul_f32 v132, v108, v116
  v_mul_f32 v133, v108, v117
  v_mul_f32 v134, v108, v118
  v_mul_f32 v135, v108, v119
  v_fmac_f32 v132, v110, v120
  v_fmac_f32 v133, v110, v121
  v_fmac_f32 v134, v110, v122
  v_fmac_f32 v135, v110, v123
  v_fmac_f32 v132, v112, v124
  v_fmac_f32 v133, v112, v125
  v_fmac_f32 v134, v112, v126
  v_fmac_f32 v135, v112, v127
  v_fmac_f32 v132, v114, v128
  v_fmac_f32 v133, v114, v129
  v_fmac_f32 v134, v114, v130
  v_fmac_f32 v135, v114, v131
  v_mul_f32 v132, v132, v29
  v_mul_f32 v133, v133, v29
  v_mul_f32 v134, v134, v29
  v_mul_f32 v135, v135, v29
  v_cvt_pk_bf16_f32 v140, v132, v133
  v_cvt_pk_bf16_f32 v142, v134, v135
  s_mov_b32 exec_hi, 0
  buffer_store_dwordx4 v[140:143], v38, s[16:19], 0 offen sc1
  s_mov_b64 exec, -1
L_x2:
  s_mov_b32 s71, 0
L_x2loop:
  buffer_load_dwordx4 v[108:111], v22, s[16:19], 0 offen sc1
  s_waitcnt vmcnt(0)
  v_xor_b32 v28, s6, v109
  v_xor_b32 v29, s6, v111
  v_or_b32 v28, v28, v29
  v_cmp_ne_u32 vcc, 0, v28
  s_add_u32 s71, s71, 1
  s_cbranch_vccz L_x2done
  s_mov_b64 exec, vcc
  s_sleep 1
  s_cmp_lt_u32 s71, 400000
  s_cbranch_scc1 L_x2loop
L_x2done:
  s_mov_b64 exec, -1
  ds_write2_b32 v25, v108, v110 offset0:0 offset1:1
  s_mov_b64 exec, 1
  ds_add_u32 v40, v41 offset:44
  s_mov_b64 exec, -1
  s_mov_b32 s71, 0
L_sp7:
  ds_read_b32 v28, v40 offset:44
  s_add_u32 s71, s71, 1
  s_waitcnt lgkmcnt(0)
  v_cmp_ne_u32 vcc, 4, v28
  s_cbranch_vccz L_sp7_done
  s_cmp_lt_u32 s71, 1600000
  s_cbranch_scc1 L_sp7
L_sp7_done:
  ds_read_b128 v[108:111], v26 offset:0
  ds_read_b128 v[112:115], v26 offset:64
  ds_read_b128 v[116:119], v26 offset:128
  ds_read_b128 v[120:123], v26 offset:192
  s_waitcnt lgkmcnt(3)
  v_mfma_f32_16x16x32_bf16 v[12:15], v[108:111], v[44:47], v[12:15]
  v_mfma_f32_16x16x32_bf16 v[16:19], v[108:111], v[60:63], v[16:19]
  s_waitcnt lgkmcnt(2)
  v_mfma_f32_16x16x32_bf16 v[12:15], v[112:115], v[48:51], v[12:15]
  v_mfma_f32_16x16x32_bf16 v[16:19], v[112:115], v[64:67], v[16:19]
  s_waitcnt lgkmcnt(1)
  v_mfma_f32_16x16x32_bf16 v[12:15], v[116:119], v[52:55], v[12:15]
  v_mfma_f32_16x16x32_bf16 v[16:19], v[116:119], v[68:71], v[16:19]
  s_waitcnt lgkmcnt(0)
  v_mfma_f32_16x16x32_bf16 v[12:15], v[120:123], v[56:59], v[12:15]
  v_mfma_f32_16x16x32_bf16 v[16:19], v[120:123], v[72:75], v[16:19]
  s_nop 7
  v_cndmask_b32 v144, v12, v16, s[82:83]
  v_cndmask_b32 v145, v13, v17, s[82:83]
  v_cndmask_b32 v146, v14, v18, s[82:83]
  v_cndmask_b32 v147, v15, v19, s[82:83]
  v_add_u32 v144, 0x80, v144
  v_add_u32 v145, 0x80, v145
  v_add_u32 v146, 0x80, v146
  v_add_u32 v147, 0x80, v147
  v_and_or_b32 v144, v144, v33, s79
  v_and_or_b32 v145, v145, v33, s79
  v_and_or_b32 v146, v146, v33, s79
  v_and_or_b32 v147, v147, v33, s79
  buffer_store_dwordx4 v[144:147], v27, s[16:19], 0 offen sc1
  s_cmp_lg_u32 s3, 4
  s_cbranch_scc1 L_end
  s_mov_b32 s71, 0
L_x3_loop:
  buffer_load_dwordx4 v[44:47], v39, s[16:19], 0 offen offset:0 sc1
  buffer_load_dwordx4 v[48:51], v39, s[16:19], 0 offen offset:1024 sc1
  buffer_load_dwordx4 v[52:55], v39, s[16:19], 0 offen offset:2048 sc1
  buffer_load_dwordx4 v[56:59], v39, s[16:19], 0 offen offset:3072 sc1
  s_waitcnt vmcnt(0)
  v_xor_b32 v30, s79, v44
  v_xor_b32 v31, s79, v45
  v_or_b32 v30, v30, v31
  v_xor_b32 v31, s79, v46
  v_xor_b32 v32, s79, v47
  v_or3_b32 v30, v30, v31, v32
  v_xor_b32 v31, s79, v48
  v_xor_b32 v32, s79, v49
  v_or3_b32 v30, v30, v31, v32
  v_xor_b32 v31, s79, v50
  v_xor_b32 v32, s79, v51
  v_or3_b32 v30, v30, v31, v32
  v_xor_b32 v31, s79, v52
  v_xor_b32 v32, s79, v53
  v_or3_b32 v30, v30, v31, v32
  v_xor_b32 v31, s79, v54
  v_xor_b32 v32, s79, v55
  v_or3_b32 v30, v30, v31, v32
  v_xor_b32 v31, s79, v56
  v_xor_b32 v32, s79, v57
  v_or3_b32 v30, v30, v31, v32
  v_xor_b32 v31, s79, v58
  v_xor_b32 v32, s79, v59
  v_or3_b32 v30, v30, v31, v32
  v_and_b32 v30, 0xff, v30
  v_cmp_ne_u32 vcc, 0, v30
  s_add_u32 s71, s71, 1
  s_cbranch_vccz L_x3_done
  s_sleep 1
  s_cmp_lt_u32 s71, 400000
  s_cbranch_scc1 L_x3_loop
L_x3_done:
  v_and_b32 v44, 0xffffff00, v44
  v_and_b32 v45, 0xffffff00, v45
  v_and_b32 v46, 0xffffff00, v46
  v_and_b32 v47, 0xffffff00, v47
  v_and_b32 v48, 0xffffff00, v48
  v_and_b32 v49, 0xffffff00, v49
  v_and_b32 v50, 0xffffff00, v50
  v_and_b32 v51, 0xffffff00, v51
  v_and_b32 v52, 0xffffff00, v52
  v_and_b32 v53, 0xffffff00, v53
  v_and_b32 v54, 0xffffff00, v54
  v_and_b32 v55, 0xffffff00, v55
  v_and_b32 v56, 0xffffff00, v56
  v_and_b32 v57, 0xffffff00, v57
  v_and_b32 v58, 0xffffff00, v58
  v_and_b32 v59, 0xffffff00, v59
  v_add_f32 v44, v44, v48
  v_add_f32 v52, v52, v56
  v_add_f32 v45, v45, v49
  v_add_f32 v53, v53, v57
  v_add_f32 v46, v46, v50
  v_add_f32 v54, v54, v58
  v_add_f32 v47, v47, v51
  v_add_f32 v55, v55, v59
  v_add_f32 v44, v44, v52
  v_add_f32 v45, v45, v53
  v_add_f32 v46, v46, v54
  v_add_f32 v47, v47, v55
  s_nop 0
  v_add_f32_dpp v44, v44, v44 row_ror:8 row_mask:0xf bank_mask:0xf
  v_add_f32_dpp v45, v45, v45 row_ror:8 row_mask:0xf bank_mask:0xf
  v_add_f32_dpp v46, v46, v46 row_ror:8 row_mask:0xf bank_mask:0xf
  v_add_f32_dpp v47, v47, v47 row_ror:8 row_mask:0xf bank_mask:0xf
  v_mov_b32 v48, v44
  v_mov_b32 v49, v45
  v_mov_b32 v50, v46
  v_mov_b32 v51, v47
  v_permlane16_swap_b32 v44, v48
  v_permlane16_swap_b32 v45, v49
  v_permlane16_swap_b32 v46, v50
  v_permlane16_swap_b32 v47, v51
  v_add_f32 v44, v44, v48
  v_add_f32 v45, v45, v49
  v_add_f32 v46, v46, v50
  v_add_f32 v47, v47, v51
  v_mov_b32 v48, v44
  v_mov_b32 v49, v45
  v_mov_b32 v50, v46
  v_mov_b32 v51, v47
  v_permlane32_swap_b32 v44, v48
  v_permlane32_swap_b32 v45, v49
  v_permlane32_swap_b32 v46, v50
  v_permlane32_swap_b32 v47, v51
  v_add_f32 v44, v44, v48
  v_add_f32 v45, v45, v49
  v_add_f32 v46, v46, v50
  v_add_f32 v47, v47, v51
  v_lshlrev_b32 v156, 16, v156
  v_lshlrev_b32 v157, 16, v157
  v_lshlrev_b32 v158, 16, v158
  v_lshlrev_b32 v159, 16, v159
  v_add_f32 v44, v44, v156
  v_add_f32 v45, v45, v157
  v_add_f32 v46, v46, v158
  v_add_f32 v47, v47, v159
  v_cvt_pk_bf16_f32 v44, v44, v45
  v_cvt_pk_bf16_f32 v46, v46, v47
  v_lshrrev_b32 v45, 16, v44
  v_lshrrev_b32 v47, 16, v46
  s_mov_b64 exec, 0xff
  buffer_store_short v44, v43, s[28:31], 0 offen
  buffer_store_short v45, v43, s[28:31], 0 offen offset:2048
  buffer_store_short v46, v42, s[28:31], 0 offen
  buffer_store_short v47, v42, s[28:31], 0 offen offset:2048
  s_mov_b64 exec, -1
  s_cmp_lg_u32 s2, 0
  s_cbranch_scc1 L_end
  v_mov_b32 v30, s6
  s_mov_b64 exec, 1
  buffer_store_dword v30, off, s[16:19], 0 sc1
  s_branch L_end
L_poller:
  s_lshl_b32 s64, s5, 3
  s_add_u32 s68, s64, s4
  s_lshl_b32 s65, s68, 13
  s_add_u32 s65, s65, 1048576
  v_lshlrev_b32 v20, 4, v1
  v_add_u32 v20, s65, v20
  v_add_u32 v21, 0x1000, v20
  v_lshlrev_b32 v22, 2, v1
  v_add_u32 v22, 133248, v22
  s_getreg_b32 s52, hwreg(HW_REG_XCC_ID, 0, 4)
  s_lshl_b32 s52, s52, 10
  s_add_u32 s52, s52, 5767168
  v_lshlrev_b32 v80, 4, v1
  v_add_u32 v80, s52, v80
  s_lshl_b32 s54, s2, 2
  s_add_u32 s54, s54, s52
  v_mov_b32 v81, s54
  s_barrier
  buffer_load_dwordx4 v[52:55], v80, s[16:19], 0 offen sc1
  s_lshl_b32 s64, s68, 9
  s_add_u32 s64, s64, 5242880
  v_and_b32 v24, 3, v1
  v_lshlrev_b32 v24, 7, v24
  v_add_u32 v24, s64, v24
  s_mov_b64 exec, 15
  buffer_load_dword v26, v24, s[16:19], 0 offen sc1
  s_mov_b64 exec, -1
  s_waitcnt vmcnt(0)
  v_readfirstlane_b32 s6, v5
  s_nop 3
  s_add_u32 s6, s6, 1
  s_and_b32 s79, s6, 0xff
  s_lshl_b32 s55, s6, 8
  s_mov_b32 s71, 0
L_sp8:
  ds_read_b32 v24, v40 offset:4
  s_add_u32 s71, s71, 1
  s_waitcnt lgkmcnt(0)
  v_cmp_ne_u32 vcc, 8, v24
  s_cbranch_vccz L_sp8_done
  s_sleep 1
  s_cmp_lt_u32 s71, 1600000
  s_cbranch_scc1 L_sp8
L_sp8_done:
  v_lshlrev_b32 v23, 10, v1
  v_add_u32 v23, s65, v23
  s_mov_b32 s71, 0
  s_mov_b64 exec, 0xff
L_lq:
  buffer_load_dwordx2 v[44:45], v23, s[16:19], 0 offen offset:896 sc1
  s_waitcnt vmcnt(0)
  v_cmp_ne_u32 vcc, s6, v45
  s_add_u32 s71, s71, 1
  s_cbranch_vccz L_lq_done
  s_cmp_lt_u32 s71, 400000
  s_cbranch_scc1 L_lq
L_lq_done:
  s_mov_b64 exec, -1
  s_lshl_b32 s65, s68, 12
  s_add_u32 s65, s65, 3145728
  v_lshlrev_b32 v62, 4, v1
  v_add_u32 v62, s65, v62
  v_and_b32 v63, 31, v1
  v_lshlrev_b32 v63, 4, v63
  s_mov_b32 s71, 0
L_pq_loop:
  buffer_load_dwordx4 v[84:87], v20, s[16:19], 0 offen offset:0 sc1
  buffer_load_dwordx4 v[88:91], v20, s[16:19], 0 offen offset:1024 sc1
  buffer_load_dwordx4 v[92:95], v20, s[16:19], 0 offen offset:2048 sc1
  buffer_load_dwordx4 v[96:99], v20, s[16:19], 0 offen offset:3072 sc1
  buffer_load_dwordx4 v[100:103], v21, s[16:19], 0 offen offset:0 sc1
  buffer_load_dwordx4 v[104:107], v21, s[16:19], 0 offen offset:1024 sc1
  buffer_load_dwordx4 v[108:111], v21, s[16:19], 0 offen offset:2048 sc1
  buffer_load_dwordx4 v[112:115], v21, s[16:19], 0 offen offset:3072 sc1
  s_waitcnt vmcnt(0)
  v_xor_b32 v30, s6, v85
  v_xor_b32 v31, s6, v87
  v_or_b32 v30, v30, v31
  v_xor_b32 v31, s6, v89
  v_xor_b32 v32, s6, v91
  v_or3_b32 v30, v30, v31, v32
  v_xor_b32 v31, s6, v93
  v_xor_b32 v32, s6, v95
  v_or3_b32 v30, v30, v31, v32
  v_xor_b32 v31, s6, v97
  v_xor_b32 v32, s6, v99
  v_or3_b32 v30, v30, v31, v32
  v_xor_b32 v31, s6, v101
  v_xor_b32 v32, s6, v103
  v_or3_b32 v30, v30, v31, v32
  v_xor_b32 v31, s6, v105
  v_xor_b32 v32, s6, v107
  v_or3_b32 v30, v30, v31, v32
  v_xor_b32 v31, s6, v109
  v_xor_b32 v32, s6, v111
  v_or3_b32 v30, v30, v31, v32
  v_xor_b32 v31, s6, v113
  v_xor_b32 v32, s6, v115
  v_or3_b32 v30, v30, v31, v32
  v_cmp_ne_u32 vcc, 0, v30
  s_add_u32 s71, s71, 1
  s_cbranch_vccz L_pq_done
  s_cmp_lt_u32 s71, 400000
  s_cbranch_scc1 L_pq_loop
L_pq_done:
  v_add_f32 v84, v84, v88
  v_add_f32 v86, v86, v90
  v_add_f32 v84, v84, v92
  v_add_f32 v86, v86, v94
  v_add_f32 v84, v84, v96
  v_add_f32 v86, v86, v98
  v_add_f32 v84, v84, v100
  v_add_f32 v86, v86, v102
  v_add_f32 v84, v84, v104
  v_add_f32 v86, v86, v106
  v_add_f32 v84, v84, v108
  v_add_f32 v86, v86, v110
  v_add_f32 v84, v84, v112
  v_add_f32 v86, v86, v114
  v_cvt_pk_bf16_f32 v84, v84, v86
  ds_write_b32 v22, v84
  s_mov_b64 exec, 1
  ds_write_b32 v40, v41 offset:8
  s_mov_b64 exec, -1
  s_waitcnt lgkmcnt(0)
  s_mov_b32 s75, 0
  s_mov_b32 s70, 0
  v_mov_b32 v26, 0
L_mon:
  ds_read_b128 v[44:47], v40 offset:16
  s_waitcnt lgkmcnt(0)
  v_min_u32 v26, v44, v45
  v_min_u32 v27, v46, v47
  v_min_u32 v26, v26, v27
  v_lshrrev_b32 v26, 1, v26
  s_cmp_lg_u32 s75, 0
  s_cbranch_scc1 L_mon_go
  v_cmp_gt_u32 vcc, 32, v26
  s_cbranch_vccnz L_mon_go
  s_mov_b32 s71, 0
L_ph_loop:
  buffer_load_dwordx4 v[44:47], v62, s[16:19], 0 offen offset:0 sc1 nt
  buffer_load_dwordx4 v[48:51], v62, s[16:19], 0 offen offset:1024 sc1 nt
  buffer_load_dwordx4 v[52:55], v62, s[16:19], 0 offen offset:2048 sc1 nt
  buffer_load_dwordx4 v[56:59], v62, s[16:19], 0 offen offset:3072 sc1 nt
  s_waitcnt vmcnt(0)
  v_xor_b32 v30, s79, v44
  v_xor_b32 v31, s79, v45
  v_or_b32 v30, v30, v31
  v_xor_b32 v31, s79, v46
  v_xor_b32 v32, s79, v47
  v_or3_b32 v30, v30, v31, v32
  v_xor_b32 v31, s79, v48
  v_xor_b32 v32, s79, v49
  v_or3_b32 v30, v30, v31, v32
  v_xor_b32 v31, s79, v50
  v_xor_b32 v32, s79, v51
  v_or3_b32 v30, v30, v31, v32
  v_xor_b32 v31, s79, v52
  v_xor_b32 v32, s79, v53
  v_or3_b32 v30, v30, v31, v32
  v_xor_b32 v31, s79, v54
  v_xor_b32 v32, s79, v55
  v_or3_b32 v30, v30, v31, v32
  v_xor_b32 v31, s79, v56
  v_xor_b32 v32, s79, v57
  v_or3_b32 v30, v30, v31, v32
  v_xor_b32 v31, s79, v58
  v_xor_b32 v32, s79, v59
  v_or3_b32 v30, v30, v31, v32
  v_and_b32 v30, 0xff, v30
  v_cmp_ne_u32 vcc, 0, v30
  s_add_u32 s71, s71, 1
  s_cbranch_vccz L_hfin
  s_sleep 16
  s_cmp_lt_u32 s71, 400000
  s_cbranch_scc1 L_ph_loop
L_hfin:
  s_mov_b32 s75, 1
  v_and_b32 v44, 0xffffff00, v44
  v_and_b32 v45, 0xffffff00, v45
  v_and_b32 v46, 0xffffff00, v46
  v_and_b32 v47, 0xffffff00, v47
  v_and_b32 v48, 0xffffff00, v48
  v_and_b32 v49, 0xffffff00, v49
  v_and_b32 v50, 0xffffff00, v50
  v_and_b32 v51, 0xffffff00, v51
  v_and_b32 v52, 0xffffff00, v52
  v_and_b32 v53, 0xffffff00, v53
  v_and_b32 v54, 0xffffff00, v54
  v_and_b32 v55, 0xffffff00, v55
  v_and_b32 v56, 0xffffff00, v56
  v_and_b32 v57, 0xffffff00, v57
  v_and_b32 v58, 0xffffff00, v58
  v_and_b32 v59, 0xffffff00, v59
  v_add_f32 v44, v44, v48
  v_add_f32 v52, v52, v56
  v_add_f32 v45, v45, v49
  v_add_f32 v53, v53, v57
  v_add_f32 v46, v46, v50
  v_add_f32 v54, v54, v58
  v_add_f32 v47, v47, v51
  v_add_f32 v55, v55, v59
  v_add_f32 v44, v44, v52
  v_add_f32 v45, v45, v53
  v_add_f32 v46, v46, v54
  v_add_f32 v47, v47, v55
  s_nop 0
  v_mov_b32 v48, v44
  v_mov_b32 v49, v45
  v_mov_b32 v50, v46
  v_mov_b32 v51, v47
  v_permlane32_swap_b32 v44, v48
  v_permlane32_swap_b32 v45, v49
  v_permlane32_swap_b32 v46, v50
  v_permlane32_swap_b32 v47, v51
  v_add_f32 v44, v44, v48
  v_add_f32 v45, v45, v49
  v_add_f32 v46, v46, v50
  v_add_f32 v47, v47, v51
  v_max_f32 v44, 0, v44
  v_max_f32 v45, 0, v45
  v_max_f32 v46, 0, v46
  v_max_f32 v47, 0, v47
  v_cvt_pk_bf16_f32 v44, v44, v45
  v_mov_b32 v45, s6
  v_cvt_pk_bf16_f32 v46, v46, v47
  v_mov_b32 v47, s6
  s_lshl_b32 s65, s68, 9
  s_add_u32 s65, s65, 5373952
  v_add_u32 v22, s65, v63
  s_mov_b32 exec_hi, 0
  buffer_store_dwordx4 v[44:47], v22, s[16:19], 0 offen sc1 nt
  s_mov_b64 exec, -1
L_mon_go:
  v_cmp_le_u32 vcc, 246, v26
  v_min_u32 v26, 255, v26
  v_or_b32 v30, s55, v26
  s_mov_b64 exec, 1
  buffer_store_dword v30, v81, s[16:19], 0 offen
  s_mov_b64 exec, -1
  s_cbranch_vccnz L_mon_exit
  buffer_load_dwordx4 v[52:55], v80, s[16:19], 0 offen sc1
  s_waitcnt vmcnt(0)
  v_mov_b32 v28, 0
  v_mov_b32 v29, 0
  v_xor_b32 v27, s55, v52
  v_cmp_gt_u32 vcc, 256, v27
  s_nop 1
  v_cndmask_b32 v27, 0, v27, vcc
  v_add_u32 v28, v28, v27
  v_addc_co_u32 v29, vcc, 0, v29, vcc
  v_xor_b32 v27, s55, v53
  v_cmp_gt_u32 vcc, 256, v27
  s_nop 1
  v_cndmask_b32 v27, 0, v27, vcc
  v_add_u32 v28, v28, v27
  v_addc_co_u32 v29, vcc, 0, v29, vcc
  v_xor_b32 v27, s55, v54
  v_cmp_gt_u32 vcc, 256, v27
  s_nop 1
  v_cndmask_b32 v27, 0, v27, vcc
  v_add_u32 v28, v28, v27
  v_addc_co_u32 v29, vcc, 0, v29, vcc
  v_xor_b32 v27, s55, v55
  v_cmp_gt_u32 vcc, 256, v27
  s_nop 1
  v_cndmask_b32 v27, 0, v27, vcc
  v_add_u32 v28, v28, v27
  v_addc_co_u32 v29, vcc, 0, v29, vcc
  v_lshl_add_u32 v28, v29, 16, v28
  s_nop 1
  v_add_u32_dpp v28, v28, v28 row_ror:8 row_mask:0xf bank_mask:0xf
  s_nop 1
  v_add_u32_dpp v28, v28, v28 row_ror:4 row_mask:0xf bank_mask:0xf
  s_nop 1
  v_add_u32_dpp v28, v28, v28 row_ror:2 row_mask:0xf bank_mask:0xf
  s_nop 1
  v_add_u32_dpp v28, v28, v28 row_ror:1 row_mask:0xf bank_mask:0xf
  v_mov_b32 v29, v28
  s_nop 1
  v_permlane16_swap_b32 v28, v29
  v_add_u32 v28, v28, v29
  v_mov_b32 v29, v28
  s_nop 1
  v_permlane32_swap_b32 v28, v29
  v_add_u32 v28, v28, v29
  v_lshrrev_b32 v29, 16, v28
  v_and_b32 v28, 0xffff, v28
  v_subrev_u32 v27, -1, v26
  v_max_i32 v27, 0, v27
  v_mul_u32_u24 v27, v27, v29
  v_cmp_gt_u32 vcc, v27, v28
  s_nop 1
  v_cndmask_b32 v29, 0, 1, vcc
  ds_write_b32 v40, v29 offset:48
  s_sleep 12
  s_add_u32 s70, s70, 1
  s_cmp_lt_u32 s70, 400000
  s_cbranch_scc1 L_mon
L_mon_exit:
  v_mov_b32 v29, 0
  ds_write_b32 v40, v29 offset:48
  s_waitcnt lgkmcnt(0)
  s_branch L_end
L_loader:
  s_min_u32 s66, s5, 27
  s_mul_i32 s64, s4, 917504
  s_lshl_b32 s65, s66, 8
  s_add_u32 s64, s64, s65
  s_add_u32 s52, s44, s64
  s_addc_u32 s53, s45, 0
  s_and_b32 s53, s53, 0xffff
  s_cmp_lt_u32 s5, 28
  s_cselect_b32 s54, 910592, 0
  s_mov_b32 s55, 0x20000
  s_lshl_b32 s64, s5, 18
  s_lshl_b32 s65, s4, 8
  s_add_u32 s64, s64, s65
  s_add_u32 s56, s40, s64
  s_addc_u32 s57, s41, 0
  s_and_b32 s57, s57, 0xffff
  s_mov_b32 s58, 260352
  s_mov_b32 s59, 0x20000
  s_lshl_b32 s64, s66, 18
  s_add_u32 s64, s64, s65
  s_add_u32 s60, s46, s64
  s_addc_u32 s61, s47, 0
  s_and_b32 s61, s61, 0xffff
  s_cmp_lt_u32 s5, 28
  s_cselect_b32 s62, 260352, 0
  s_mov_b32 s63, 0x20000
  v_mul_u32_u24 v10, 7168, v2
  v_add_u32 v11, v10, v9
  v_add_u32 v10, v10, v8
  v_lshlrev_b32 v12, 11, v2
  v_add_u32 v13, v12, v9
  v_add_u32 v12, v12, v8
  s_barrier
  s_mov_b32 s64, 0
  s_mov_b32 s65, 32768
L_t_w1:
  s_mov_b32 m0, s65
  s_add_u32 s65, s65, 1024
  buffer_load_dwordx4 v10, s[52:55], s64 offen nt lds
  s_add_u32 s64, s64, 28672
  s_waitcnt vmcnt(31)
  s_mov_b32 m0, s65
  s_add_u32 s65, s65, 1024
  buffer_load_dwordx4 v10, s[52:55], s64 offen nt lds
  s_add_u32 s64, s64, 28672
  s_waitcnt vmcnt(31)
  s_mov_b32 m0, s65
  s_add_u32 s65, s65, 1024
  buffer_load_dwordx4 v11, s[52:55], s64 offen nt lds
  s_add_u32 s64, s64, 28672
  s_waitcnt vmcnt(31)
  s_mov_b32 m0, s65
  s_add_u32 s65, s65, 1024
  buffer_load_dwordx4 v11, s[52:55], s64 offen nt lds
  s_add_u32 s64, s64, 28672
  s_waitcnt vmcnt(31)
  s_cmp_lt_u32 s65, 65536
  s_cbranch_scc1 L_t_w1
  s_mov_b32 s64, 0
  s_mov_b32 s65, 65536
L_t_wo:
  s_mov_b32 m0, s65
  s_add_u32 s65, s65, 1024
  buffer_load_dwordx4 v12, s[56:59], s64 offen nt lds
  s_add_u32 s64, s64, 8192
  s_waitcnt vmcnt(31)
  s_mov_b32 m0, s65
  s_add_u32 s65, s65, 1024
  buffer_load_dwordx4 v12, s[56:59], s64 offen nt lds
  s_add_u32 s64, s64, 8192
  s_waitcnt vmcnt(31)
  s_mov_b32 m0, s65
  s_add_u32 s65, s65, 1024
  buffer_load_dwordx4 v13, s[56:59], s64 offen nt lds
  s_add_u32 s64, s64, 8192
  s_waitcnt vmcnt(31)
  s_mov_b32 m0, s65
  s_add_u32 s65, s65, 1024
  buffer_load_dwordx4 v13, s[56:59], s64 offen nt lds
  s_add_u32 s64, s64, 8192
  s_waitcnt vmcnt(31)
  s_cmp_lt_u32 s65, 98304
  s_cbranch_scc1 L_t_wo
  s_waitcnt vmcnt(32)
  s_mov_b64 exec, 1
  ds_add_u32 v40, v41 offset:56
  s_mov_b64 exec, -1
  s_mov_b32 s64, 0
  s_mov_b32 s65, 98304
L_t_w2:
  s_mov_b32 m0, s65
  s_add_u32 s65, s65, 1024
  buffer_load_dwordx4 v12, s[60:63], s64 offen nt lds
  s_add_u32 s64, s64, 8192
  s_waitcnt vmcnt(31)
  s_mov_b32 m0, s65
  s_add_u32 s65, s65, 1024
  buffer_load_dwordx4 v12, s[60:63], s64 offen nt lds
  s_add_u32 s64, s64, 8192
  s_waitcnt vmcnt(31)
  s_mov_b32 m0, s65
  s_add_u32 s65, s65, 1024
  buffer_load_dwordx4 v13, s[60:63], s64 offen nt lds
  s_add_u32 s64, s64, 8192
  s_waitcnt vmcnt(31)
  s_mov_b32 m0, s65
  s_add_u32 s65, s65, 1024
  buffer_load_dwordx4 v13, s[60:63], s64 offen nt lds
  s_add_u32 s64, s64, 8192
  s_waitcnt vmcnt(31)
  s_cmp_lt_u32 s65, 131072
  s_cbranch_scc1 L_t_w2
  s_mov_b64 exec, 1
  ds_add_u32 v40, v41 offset:52
  s_mov_b64 exec, -1
  s_waitcnt vmcnt(0)
  s_mov_b64 exec, 1
  ds_add_u32 v40, v41 offset:32
  s_mov_b64 exec, -1
  s_waitcnt lgkmcnt(0)
L_end:
L_exit:
  s_endpgm
.section .rodata,"a"
.p2align 6
.amdhsa_kernel parallel_sum__mha_block_cached__dense_activation_relu__decode_kernel
  .amdhsa_next_free_vgpr 168
  .amdhsa_next_free_sgpr 96
  .amdhsa_accum_offset 168
  .amdhsa_group_segment_fixed_size 0
  .amdhsa_kernarg_size 88
  .amdhsa_user_sgpr_count 2
  .amdhsa_user_sgpr_kernarg_segment_ptr 1
  .amdhsa_system_sgpr_workgroup_id_x 1
  .amdhsa_float_denorm_mode_32 3
.end_amdhsa_kernel
```
